```python
import torch

def _softmax(x, axis=-1):
    return torch.softmax(x, dim=axis)
def _gelu(x):
    return torch.nn.functional.gelu(x, approximate="tanh")
def _silu(x):
    return torch.nn.functional.silu(x)
def _sigmoid(x):
    return torch.sigmoid(x)
def _layernorm(x, axis=-1, eps=1e-5):
    m = x.mean(dim=axis, keepdim=True)
    v = x.var(dim=axis, keepdim=True, unbiased=False)
    return (x - m) / torch.sqrt(v + eps)
def _scatter_add(tgt, idx, src, axis=0):
    return tgt.clone().index_add_(axis, idx, src)
def _segment_sum(src, seg, n):
    out = torch.zeros((n,) + src.shape[1:], dtype=src.dtype)
    return out.index_add_(0, seg, src)
def _pad(x, pw):
    flat = tuple(v for pair in reversed(pw) for v in pair)
    return torch.nn.functional.pad(x, flat)

kernel_name = 'sequential_preLN__ssm_conv_s4d__mixer_channel_mlp__prompt'

def setup_inputs():

    _w = (lambda a: (lambda t: t.to(torch.bfloat16) if t.is_floating_point() else t)(torch.as_tensor(a)))
    def _A_setup():
        Bsz, L, D, N = 1, 2048, 448, 256
        return {
            "u": _w((lambda *s: torch.randn(*s, dtype=torch.bfloat16) * 0.05)(Bsz, L, D)),
            "log_A_real": _w((lambda *s: torch.randn(*s, dtype=torch.bfloat16) * 3.2)(D, N) * 0.5),
            "A_imag": _w((lambda *s: torch.randn(*s, dtype=torch.bfloat16) * 0.05)(D, N) * 3.14),
            "C_real": _w((lambda *s: torch.randn(*s, dtype=torch.bfloat16) * 0.1)(D, N) / N ** 0.5),
            "C_imag": _w((lambda *s: torch.randn(*s, dtype=torch.bfloat16) * 0.1)(D, N) / N ** 0.5),
            "log_dt": _w((lambda *s: torch.randn(*s, dtype=torch.bfloat16) * 0.05)(D) * 0.5 - 4.0),
            "D_skip": _w((lambda *s: torch.randn(*s, dtype=torch.bfloat16) * 0.05)(D)),
        }
    _A_in = _A_setup()

    def _B_setup():
        B, S, D, F = 1, 2048, 448, 1792
        return {
            "x": _w((lambda *s: torch.randn(*s, dtype=torch.bfloat16) * 0.05)(B, S, D)),
            "w1": _w((lambda *s: torch.randn(*s, dtype=torch.bfloat16) * 1.6)(D, F) * (D ** -0.5)),
            "b1": _w((lambda *s: torch.randn(*s, dtype=torch.bfloat16) * 0.8)(F)),
            "w2": _w((lambda *s: torch.randn(*s, dtype=torch.bfloat16) * 0.05)(F, D) * (F ** -0.5)),
            "b2": _w((lambda *s: torch.randn(*s, dtype=torch.bfloat16) * 0.05)(D)),
        }
    _B_in = _B_setup()

    return {
        "A_u": _A_in["u"],
        "A_log_A_real": _A_in["log_A_real"],
        "A_A_imag": _A_in["A_imag"],
        "A_C_real": _A_in["C_real"],
        "A_C_imag": _A_in["C_imag"],
        "A_log_dt": _A_in["log_dt"],
        "A_D_skip": _A_in["D_skip"],
        "B_x": _B_in["x"],
        "B_w1": _B_in["w1"],
        "B_b1": _B_in["b1"],
        "B_w2": _B_in["w2"],
        "B_b2": _B_in["b2"],
    }

def reference(A_u, A_log_A_real, A_A_imag, A_C_real, A_C_imag, A_log_dt, A_D_skip, B_x, B_w1, B_b1, B_w2, B_b2):
    def _A_ref(u, log_A_real, A_imag, C_real, C_imag, log_dt, D_skip):
        L = u.shape[1]
        dt = torch.exp(log_dt)
        A = -torch.exp(log_A_real) + 1j * A_imag
        C = (C_real + 1j * C_imag) * dt[:, None]
        pos = (lambda x, dt: x.to(dt))(torch.arange(L), log_dt.dtype)
        P = torch.exp((A * dt[:, None])[:, :, None] * pos[None, None, :])
        K = 2.0 * torch.einsum("dn,dnl->dl", C, P).real
        L2 = 2 * L
        u_t = (lambda x, *d: x.permute(*d))(u, 0, 2, 1)
        Kf = (lambda x, *a, **k: torch.fft.rfft(x.float(), *a, **k))(K, L2)
        Uf = (lambda x, *a, **k: torch.fft.rfft(x.float(), *a, **k))(u_t, L2)
        y = (lambda x, *a, **k: torch.fft.irfft(x, *a, **k).to(torch.bfloat16))(Uf * Kf[None, :, :], L2)[:, :, :L]
        y = (lambda x, *d: x.permute(*d))(y, 0, 2, 1)
        return y + u * D_skip[None, None, :]

    def _B_ref(x, w1, b1, w2, b2):
        y = _layernorm(x, axis=-1)
        h = _gelu(torch.einsum("bsd,df->bsf", y, w1) + b1)
        return torch.einsum("bsf,fd->bsd", h, w2) + b2

    x = A_u
    h = x + _A_ref(_layernorm(x, axis=-1), A_log_A_real, A_A_imag, A_C_real, A_C_imag, A_log_dt, A_D_skip)
    h2 = h + _B_ref(_layernorm(h, axis=-1), B_w1, B_b1, B_w2, B_b2)
    return h2
```

```asm
; @launch grid=(256,1,1) block=(512,1,1) lds=154880
.amdgcn_target "amdgcn-amd-amdhsa--gfx950"
.text
.globl sequential_preLN__ssm_conv_s4d__mixer_channel_mlp__prompt_kernel
.p2align 8
.type sequential_preLN__ssm_conv_s4d__mixer_channel_mlp__prompt_kernel,@function
sequential_preLN__ssm_conv_s4d__mixer_channel_mlp__prompt_kernel:
  s_getpc_b64 s[68:69]
  v_lshlrev_b32 v11, 7, v0
  v_min_u32 v11, 34340, v11
  global_load_dword v255, v11, s[68:69]
  s_load_dwordx16 s[4:19], s[0:1], 0
  s_load_dwordx2 s[32:33], s[0:1], 112
  s_load_dwordx8 s[20:27], s[0:1], 64
  s_load_dwordx4 s[28:31], s[0:1], 96
  s_getpc_b64 s[68:69]
  s_cmp_ge_u32 s2, 256
  s_cbranch_scc1 Lend
  v_lshrrev_b32 v11, 6, v0
  v_and_b32 v1, 63, v0
  v_readfirstlane_b32 s35, v11
  s_sub_u32 s36, s2, 32
  s_cselect_b32 s42, 0, s36
  s_lshr_b32 s43, s42, 3
  s_and_b32 s42, s42, 7
  s_mul_i32 s37, s42, 28
  s_add_u32 s37, s37, s43
  s_lshr_b32 s39, s43, 2
  s_and_b32 s43, s43, 3
  s_lshl_b32 s42, s42, 2
  s_add_u32 s38, s42, s43
  s_lshl_b32 s42, s37, 10
  v_and_b32 v28, 255, v0
  v_lshl_add_u32 v28, v28, 2, s42
  s_lshl_b32 s49, s37, 2
  s_mul_i32 s3, s2, 7168
  s_cmp_eq_u32 s35, 7
  s_cselect_b32 s42, 0, s35
  s_lshl_b32 s42, s42, 7
  s_add_u32 s46, s42, s3
  v_lshrrev_b32 v15, 3, v1
  v_and_b32 v14, 7, v1
  v_mul_u32_u24 v12, 896, v15
  v_lshl_add_u32 v12, v14, 4, v12
  v_and_b32 v11, 3, v0
  v_lshrrev_b32 v16, 2, v0
  v_mul_u32_u24 v18, 3584, v16
  v_lshl_add_u32 v18, v11, 4, v18
  s_lshr_b32 s50, s37, 3
  s_lshl_b32 s50, s50, 1
  s_and_b32 s42, s37, 1
  s_add_u32 s50, s50, s42
  s_bfe_u32 s51, s37, 0x20001
  s_mul_i32 s48, s51, 401408
  s_lshl_b32 s43, s50, 6
  s_add_u32 s48, s48, s43
  v_lshlrev_b32 v13, 4, v0
  s_waitcnt lgkmcnt(0)
  s_add_u32 s44, s4, s46
  s_addc_u32 s45, s5, 0
  global_load_dwordx4 v[64:67], v12, s[44:45]
  s_load_dword s34, s[32:33], 0
  s_load_dword s40, s[14:15], s49
  global_load_dword v29, v28, s[6:7]
  global_load_dword v30, v28, s[8:9]
  global_load_dword v31, v28, s[10:11]
  global_load_dword v32, v28, s[12:13]
  s_load_dword s41, s[16:17], s49
  s_cmp_eq_u32 s35, 7
  s_cbranch_scc0 Lc1
  global_load_dwordx4 v[68:71], v12, s[44:45] offset:128
  global_load_dwordx4 v[72:75], v12, s[44:45] offset:256
  global_load_dwordx4 v[76:79], v12, s[44:45] offset:384
  global_load_dwordx4 v[80:83], v12, s[44:45] offset:512
  global_load_dwordx4 v[84:87], v12, s[44:45] offset:640
  global_load_dwordx4 v[88:91], v12, s[44:45] offset:768
Lc1:
  s_cmp_lt_u32 s2, 32
  s_cbranch_scc1 Lhelper
  s_lshl_b32 s42, s3, 1
  s_add_u32 s42, s42, 134656
  s_add_u32 s46, s32, s42
  s_addc_u32 s47, s33, 0
  s_mul_i32 s42, s35, 1280
  s_add_u32 s42, s42, 129024
  v_mul_u32_u24 v15, 160, v15
  v_lshl_add_u32 v14, v14, 4, v15
  v_add_u32 v14, s42, v14
  v_and_b32 v15, 3, v1
  v_mul_u32_u24 v15, 320, v15
  v_lshrrev_b32 v16, 2, v1
  v_lshl_add_u32 v15, v16, 3, v15
  v_add_u32 v15, s42, v15
  v_and_b32 v11, 255, v0
  v_lshlrev_b32 v11, 3, v11
  v_sub_u32 v11, 2047, v11
  v_cvt_f32_u32 v11, v11
  s_lshr_b32 s42, s35, 2
  s_mul_i32 s42, s42, 60416
  v_add_f32 v34, 0x0, v11
  v_add_f32 v35, 0xbf800000, v11
  v_add_f32 v36, 0xc0000000, v11
  v_add_f32 v37, 0xc0400000, v11
  v_add_f32 v38, 0xc0800000, v11
  v_add_f32 v39, 0xc0a00000, v11
  v_add_f32 v40, 0xc0c00000, v11
  v_add_f32 v41, 0xc0e00000, v11
  v_add_f32 v42, 0xc1000000, v11
  v_max_f32 v42, 0, v42
  v_cvt_pk_bf16_f32 v34, v34, v35
  v_cvt_pk_bf16_f32 v36, v36, v37
  v_cvt_pk_bf16_f32 v38, v38, v39
  v_cvt_pk_bf16_f32 v40, v40, v41
  v_cvt_pk_bf16_f32 v42, v42, v42
  v_and_b32 v35, 0xffff0000, v34
  v_lshlrev_b32 v34, 16, v34
  v_and_b32 v37, 0xffff0000, v36
  v_lshlrev_b32 v36, 16, v36
  v_and_b32 v39, 0xffff0000, v38
  v_lshlrev_b32 v38, 16, v38
  v_and_b32 v41, 0xffff0000, v40
  v_lshlrev_b32 v40, 16, v40
  v_lshlrev_b32 v42, 16, v42
  v_cvt_u32_f32 v34, v34
  v_cvt_u32_f32 v35, v35
  v_cvt_u32_f32 v36, v36
  v_cvt_u32_f32 v37, v37
  v_cvt_u32_f32 v38, v38
  v_cvt_u32_f32 v39, v39
  v_cvt_u32_f32 v40, v40
  v_cvt_u32_f32 v41, v41
  v_cvt_u32_f32 v42, v42
  v_lshrrev_b32 v2, 8, v34
  v_and_b32 v11, 7, v34
  v_lshl_add_u32 v2, v2, 3, v11
  v_bfe_u32 v11, v34, 3, 5
  v_lshl_add_u32 v2, v2, 5, v11
  v_lshl_add_u32 v2, v2, 2, s42
  v_lshrrev_b32 v3, 8, v35
  v_and_b32 v11, 7, v35
  v_lshl_add_u32 v3, v3, 3, v11
  v_bfe_u32 v11, v35, 3, 5
  v_lshl_add_u32 v3, v3, 5, v11
  v_lshl_add_u32 v3, v3, 2, s42
  v_lshrrev_b32 v4, 8, v36
  v_and_b32 v11, 7, v36
  v_lshl_add_u32 v4, v4, 3, v11
  v_bfe_u32 v11, v36, 3, 5
  v_lshl_add_u32 v4, v4, 5, v11
  v_lshl_add_u32 v4, v4, 2, s42
  v_lshrrev_b32 v5, 8, v37
  v_and_b32 v11, 7, v37
  v_lshl_add_u32 v5, v5, 3, v11
  v_bfe_u32 v11, v37, 3, 5
  v_lshl_add_u32 v5, v5, 5, v11
  v_lshl_add_u32 v5, v5, 2, s42
  v_lshrrev_b32 v6, 8, v38
  v_and_b32 v11, 7, v38
  v_lshl_add_u32 v6, v6, 3, v11
  v_bfe_u32 v11, v38, 3, 5
  v_lshl_add_u32 v6, v6, 5, v11
  v_lshl_add_u32 v6, v6, 2, s42
  v_lshrrev_b32 v7, 8, v39
  v_and_b32 v11, 7, v39
  v_lshl_add_u32 v7, v7, 3, v11
  v_bfe_u32 v11, v39, 3, 5
  v_lshl_add_u32 v7, v7, 5, v11
  v_lshl_add_u32 v7, v7, 2, s42
  v_lshrrev_b32 v8, 8, v40
  v_and_b32 v11, 7, v40
  v_lshl_add_u32 v8, v8, 3, v11
  v_bfe_u32 v11, v40, 3, 5
  v_lshl_add_u32 v8, v8, 5, v11
  v_lshl_add_u32 v8, v8, 2, s42
  v_lshrrev_b32 v9, 8, v41
  v_and_b32 v11, 7, v41
  v_lshl_add_u32 v9, v9, 3, v11
  v_bfe_u32 v11, v41, 3, 5
  v_lshl_add_u32 v9, v9, 5, v11
  v_lshl_add_u32 v9, v9, 2, s42
  v_lshrrev_b32 v10, 8, v42
  v_and_b32 v11, 7, v42
  v_lshl_add_u32 v10, v10, 3, v11
  v_bfe_u32 v11, v42, 3, 5
  v_lshl_add_u32 v10, v10, 5, v11
  v_lshl_add_u32 v10, v10, 2, s42
  s_waitcnt lgkmcnt(0)
  s_xor_b32 s34, s34, 0x5bd1e995
  s_cmp_eq_u32 s35, 7
  s_cbranch_scc1 Lc2
  s_waitcnt vmcnt(4)
  ds_write_b128 v14, v[64:67]
  ds_read_b32 v20, v15
  ds_read_b32 v22, v15 offset:160
  ds_read_b32 v24, v15 offset:4
  ds_read_b32 v26, v15 offset:164
  v_mov_b32 v21, s34
  v_mov_b32 v23, s34
  v_mov_b32 v25, s34
  v_mov_b32 v27, s34
  s_waitcnt lgkmcnt(2)
  global_store_dwordx4 v13, v[20:23], s[46:47] offset:-3584 sc1
  s_waitcnt lgkmcnt(0)
  global_store_dwordx4 v13, v[24:27], s[46:47] offset:3584 sc1
  s_mul_i32 s42, s37, 7168
  s_add_u32 s52, s20, s42
  s_addc_u32 s53, s21, 0
  global_load_dwordx4 v[92:95], v13, s[52:53]
  s_mul_i32 s42, s37, 7168
  s_add_u32 s52, s24, s42
  s_addc_u32 s53, s25, 0
  global_load_dwordx4 v[96:99], v13, s[52:53]
  s_waitcnt vmcnt(4)
Lc2:
  s_cmp_eq_u32 s35, 7
  s_cbranch_scc0 Lc3
  s_setprio 3
  v_mov_b32 v14, 0x3f803f80
  v_mov_b32 v16, 0
  v_mov_b32 v17, 0
  v_mov_b32 v18, 0
  v_mov_b32 v19, 0
  s_waitcnt vmcnt(10)
  v_dot2c_f32_bf16 v16, v64, v14
  v_dot2c_f32_bf16 v18, v64, v64
  v_dot2c_f32_bf16 v17, v65, v14
  v_dot2c_f32_bf16 v19, v65, v65
  v_dot2c_f32_bf16 v16, v66, v14
  v_dot2c_f32_bf16 v18, v66, v66
  v_dot2c_f32_bf16 v17, v67, v14
  v_dot2c_f32_bf16 v19, v67, v67
  s_waitcnt vmcnt(5)
  v_dot2c_f32_bf16 v16, v68, v14
  v_dot2c_f32_bf16 v18, v68, v68
  v_dot2c_f32_bf16 v17, v69, v14
  v_dot2c_f32_bf16 v19, v69, v69
  v_dot2c_f32_bf16 v16, v70, v14
  v_dot2c_f32_bf16 v18, v70, v70
  v_dot2c_f32_bf16 v17, v71, v14
  v_dot2c_f32_bf16 v19, v71, v71
  s_waitcnt vmcnt(4)
  v_dot2c_f32_bf16 v16, v72, v14
  v_dot2c_f32_bf16 v18, v72, v72
  v_dot2c_f32_bf16 v17, v73, v14
  v_dot2c_f32_bf16 v19, v73, v73
  v_dot2c_f32_bf16 v16, v74, v14
  v_dot2c_f32_bf16 v18, v74, v74
  v_dot2c_f32_bf16 v17, v75, v14
  v_dot2c_f32_bf16 v19, v75, v75
  s_waitcnt vmcnt(3)
  v_dot2c_f32_bf16 v16, v76, v14
  v_dot2c_f32_bf16 v18, v76, v76
  v_dot2c_f32_bf16 v17, v77, v14
  v_dot2c_f32_bf16 v19, v77, v77
  v_dot2c_f32_bf16 v16, v78, v14
  v_dot2c_f32_bf16 v18, v78, v78
  v_dot2c_f32_bf16 v17, v79, v14
  v_dot2c_f32_bf16 v19, v79, v79
  s_waitcnt vmcnt(2)
  v_dot2c_f32_bf16 v16, v80, v14
  v_dot2c_f32_bf16 v18, v80, v80
  v_dot2c_f32_bf16 v17, v81, v14
  v_dot2c_f32_bf16 v19, v81, v81
  v_dot2c_f32_bf16 v16, v82, v14
  v_dot2c_f32_bf16 v18, v82, v82
  v_dot2c_f32_bf16 v17, v83, v14
  v_dot2c_f32_bf16 v19, v83, v83
  s_waitcnt vmcnt(1)
  v_dot2c_f32_bf16 v16, v84, v14
  v_dot2c_f32_bf16 v18, v84, v84
  v_dot2c_f32_bf16 v17, v85, v14
  v_dot2c_f32_bf16 v19, v85, v85
  v_dot2c_f32_bf16 v16, v86, v14
  v_dot2c_f32_bf16 v18, v86, v86
  v_dot2c_f32_bf16 v17, v87, v14
  v_dot2c_f32_bf16 v19, v87, v87
  s_waitcnt vmcnt(0)
  v_dot2c_f32_bf16 v16, v88, v14
  v_dot2c_f32_bf16 v18, v88, v88
  v_dot2c_f32_bf16 v17, v89, v14
  v_dot2c_f32_bf16 v19, v89, v89
  v_dot2c_f32_bf16 v16, v90, v14
  v_dot2c_f32_bf16 v18, v90, v90
  v_dot2c_f32_bf16 v17, v91, v14
  v_dot2c_f32_bf16 v19, v91, v91
  s_nop 1
  v_add_f32 v16, v16, v17
  v_add_f32 v18, v18, v19
  s_nop 0
  v_add_f32_dpp v16, v16, v16 quad_perm:[1,0,3,2] row_mask:0xf bank_mask:0xf
  v_add_f32_dpp v18, v18, v18 quad_perm:[1,0,3,2] row_mask:0xf bank_mask:0xf
  s_nop 0
  v_add_f32_dpp v16, v16, v16 quad_perm:[2,3,0,1] row_mask:0xf bank_mask:0xf
  v_add_f32_dpp v18, v18, v18 quad_perm:[2,3,0,1] row_mask:0xf bank_mask:0xf
  s_nop 0
  v_add_f32_dpp v16, v16, v16 row_half_mirror row_mask:0xf bank_mask:0xf
  v_add_f32_dpp v18, v18, v18 row_half_mirror row_mask:0xf bank_mask:0xf
  v_mul_f32 v16, 0x3b124925, v16
  v_mul_f32 v18, 0x3b124925, v18
  v_fma_f32 v18, -v16, v16, v18
  v_max_f32 v18, 0, v18
  v_cvt_pk_bf16_f32 v18, v18, v18
  v_and_b32 v18, 0xffff0000, v18
  v_add_f32 v18, 0x3727c5ac, v18
  v_cvt_pk_bf16_f32 v18, v18, v18
  v_and_b32 v18, 0xffff0000, v18
  v_sqrt_f32 v18, v18
  v_mov_b32 v15, s34
  v_cvt_pk_bf16_f32 v14, v16, v18
  v_and_b32 v11, 7, v1
  v_cmp_eq_u32 vcc, 0, v11
  s_lshl_b32 s42, s2, 6
  s_add_u32 s42, s42, 65536
  s_add_u32 s46, s32, s42
  s_addc_u32 s47, s33, 0
  s_and_saveexec_b64 s[48:49], vcc
  global_store_dwordx2 v1, v[14:15], s[46:47] sc1
  s_mov_b64 exec, s[48:49]
  s_setprio 0
Lc3:
  s_mov_b32 s16, s50
  s_lshl_b32 s50, s39, 3
  s_add_u32 s50, s50, s35
  s_lshl_b32 s42, s50, 6
  s_and_b32 s51, s38, 1
  s_mul_i32 s43, s51, 802816
  s_add_u32 s42, s42, s43
  s_lshl_b32 s3, s43, 1
  v_lshrrev_b32 v142, 2, v1
  v_and_b32 v143, 3, v1
  v_mul_u32_u24 v142, 3584, v142
  v_lshl_add_u32 v100, v143, 4, v142
  s_add_u32 s14, s20, s42
  s_addc_u32 s15, s21, 0
  s_cmp_ge_u32 s35, 4
  s_cbranch_scc1 LB
  v_mov_b32 v141, v100
  s_and_b32 s42, s35, 2
  s_lshl_b32 s42, s42, 3
  s_lshr_b32 s43, s40, s42
  s_lshl_b32 s43, s43, 16
  s_mov_b32 s48, 0x3fb8aa3b
  v_mov_b32 v39, s43
  v_mul_f32 v38, s48, v39
  v_fma_f32 v40, s48, v39, -v38
  v_fmac_f32 v40, 0x32a57060, v39
  v_exp_f32 v38, v38
  v_mul_f32 v40, 0x3f317218, v40
  v_fmac_f32 v38, v38, v40
  v_cvt_pk_bf16_f32 v38, v38, v38
  v_and_b32 v38, 0xffff0000, v38
  s_and_b32 s42, s35, 3
  s_mul_i32 s42, s42, 30208
  s_add_u32 s54, s42, 0
  v_lshl_add_u32 v33, v1, 3, s54
  v_lshlrev_b32 v34, 16, v29
  v_and_b32 v35, 0xffff0000, v29
  v_mul_f32 v34, s48, v34
  v_mul_f32 v35, s48, v35
  v_exp_f32 v34, v34
  v_exp_f32 v35, v35
  v_lshlrev_b32 v36, 16, v30
  v_and_b32 v37, 0xffff0000, v30
  v_cvt_pk_bf16_f32 v35, v34, v35
  v_mul_f32 v36, v38, v36
  v_mul_f32 v37, v38, v37
  v_lshlrev_b32 v34, 16, v35
  v_and_b32 v35, 0xffff0000, v35
  v_mul_f32 v34, v38, v34
  v_mul_f32 v35, v38, v35
  v_mul_f32 v36, 0x3e22f983, v36
  v_mul_f32 v37, 0x3e22f983, v37
  v_mul_f32 v34, 0xbfb8aa3b, v34
  v_mul_f32 v35, 0xbfb8aa3b, v35
  v_mul_f32 v60, 0x41000000, v34
  v_mul_f32 v61, 0x41000000, v35
  v_mul_f32 v62, 0x41000000, v36
  v_mul_f32 v63, 0x41000000, v37
  v_exp_f32 v60, v60
  v_exp_f32 v61, v61
  v_fract_f32 v62, v62
  v_fract_f32 v63, v63
  v_cos_f32 v40, v62
  v_cos_f32 v41, v63
  v_sin_f32 v42, v62
  v_sin_f32 v43, v63
  v_pk_mul_f32 v[40:41], v[40:41], v[60:61]
  v_pk_mul_f32 v[42:43], v[42:43], v[60:61]
  v_mul_f32 v60, 0x43000000, v34
  v_mul_f32 v61, 0x43000000, v35
  v_mul_f32 v62, 0x43000000, v36
  v_mul_f32 v63, 0x43000000, v37
  v_exp_f32 v60, v60
  v_exp_f32 v61, v61
  v_fract_f32 v62, v62
  v_fract_f32 v63, v63
  v_cos_f32 v48, v62
  v_cos_f32 v49, v63
  v_sin_f32 v50, v62
  v_sin_f32 v51, v63
  v_pk_mul_f32 v[48:49], v[48:49], v[60:61]
  v_pk_mul_f32 v[50:51], v[50:51], v[60:61]
  v_mov_b32 v128, 0x3f803f80
  v_mov_b32 v129, 0
  ds_write_b64 v33, v[128:129]
  v_cvt_pk_bf16_f32 v130, v40, v41
  global_load_dwordx4 v[144:147], v141, s[14:15]
  s_add_u32 s14, s14, 57344
  s_addc_u32 s15, s15, 0
  v_cvt_pk_bf16_f32 v134, v48, v49
  v_cvt_pk_bf16_f32 v131, v42, v43
  v_cvt_pk_bf16_f32 v135, v50, v51
  ds_write_b64 v33, v[130:131] offset:528
  ds_write_b64 v33, v[134:135] offset:8448
  v_pk_mul_f32 v[52:53], v[40:41], v[40:41]
  v_pk_mul_f32 v[56:57], v[48:49], v[40:41]
  v_pk_mul_f32 v[54:55], v[40:41], v[42:43]
  v_pk_mul_f32 v[58:59], v[48:49], v[42:43]
  v_pk_fma_f32 v[44:45], v[42:43], v[42:43], v[52:53] neg_lo:[1,0,0] neg_hi:[1,0,0]
  v_pk_fma_f32 v[48:49], v[50:51], v[42:43], v[56:57] neg_lo:[1,0,0] neg_hi:[1,0,0]
  v_pk_fma_f32 v[46:47], v[42:43], v[40:41], v[54:55]
  v_pk_fma_f32 v[50:51], v[50:51], v[40:41], v[58:59]
  v_cvt_pk_bf16_f32 v132, v44, v45
  global_load_dwordx4 v[148:151], v141, s[14:15]
  s_add_u32 s14, s14, 57344
  s_addc_u32 s15, s15, 0
  v_cvt_pk_bf16_f32 v136, v48, v49
  v_cvt_pk_bf16_f32 v133, v46, v47
  v_cvt_pk_bf16_f32 v137, v50, v51
  ds_write_b64 v33, v[132:133] offset:1056
  ds_write_b64 v33, v[136:137] offset:8976
  v_pk_mul_f32 v[52:53], v[44:45], v[40:41]
  v_pk_mul_f32 v[56:57], v[48:49], v[40:41]
  v_pk_mul_f32 v[54:55], v[44:45], v[42:43]
  v_pk_mul_f32 v[58:59], v[48:49], v[42:43]
  v_pk_fma_f32 v[44:45], v[46:47], v[42:43], v[52:53] neg_lo:[1,0,0] neg_hi:[1,0,0]
  v_pk_fma_f32 v[48:49], v[50:51], v[42:43], v[56:57] neg_lo:[1,0,0] neg_hi:[1,0,0]
  v_pk_fma_f32 v[46:47], v[46:47], v[40:41], v[54:55]
  v_pk_fma_f32 v[50:51], v[50:51], v[40:41], v[58:59]
  v_cvt_pk_bf16_f32 v128, v44, v45
  v_cvt_pk_bf16_f32 v138, v48, v49
  global_load_dwordx4 v[152:155], v141, s[14:15]
  s_add_u32 s14, s14, 57344
  s_addc_u32 s15, s15, 0
  v_cvt_pk_bf16_f32 v129, v46, v47
  v_cvt_pk_bf16_f32 v139, v50, v51
  ds_write_b64 v33, v[128:129] offset:1584
  ds_write_b64 v33, v[138:139] offset:9504
  v_pk_mul_f32 v[52:53], v[44:45], v[40:41]
  v_pk_mul_f32 v[56:57], v[48:49], v[40:41]
  v_pk_mul_f32 v[54:55], v[44:45], v[42:43]
  v_pk_mul_f32 v[58:59], v[48:49], v[42:43]
  v_pk_fma_f32 v[44:45], v[46:47], v[42:43], v[52:53] neg_lo:[1,0,0] neg_hi:[1,0,0]
  v_pk_fma_f32 v[48:49], v[50:51], v[42:43], v[56:57] neg_lo:[1,0,0] neg_hi:[1,0,0]
  v_pk_fma_f32 v[46:47], v[46:47], v[40:41], v[54:55]
  v_pk_fma_f32 v[50:51], v[50:51], v[40:41], v[58:59]
  v_cvt_pk_bf16_f32 v130, v44, v45
  v_cvt_pk_bf16_f32 v134, v48, v49
  v_cvt_pk_bf16_f32 v131, v46, v47
  global_load_dwordx4 v[156:159], v141, s[14:15]
  s_add_u32 s14, s14, 57344
  s_addc_u32 s15, s15, 0
  v_cvt_pk_bf16_f32 v135, v50, v51
  ds_write_b64 v33, v[130:131] offset:2112
  ds_write_b64 v33, v[134:135] offset:10032
  v_pk_mul_f32 v[52:53], v[44:45], v[40:41]
  v_pk_mul_f32 v[56:57], v[48:49], v[40:41]
  v_pk_mul_f32 v[54:55], v[44:45], v[42:43]
  v_pk_mul_f32 v[58:59], v[48:49], v[42:43]
  v_pk_fma_f32 v[44:45], v[46:47], v[42:43], v[52:53] neg_lo:[1,0,0] neg_hi:[1,0,0]
  v_pk_fma_f32 v[48:49], v[50:51], v[42:43], v[56:57] neg_lo:[1,0,0] neg_hi:[1,0,0]
  v_pk_fma_f32 v[46:47], v[46:47], v[40:41], v[54:55]
  v_pk_fma_f32 v[50:51], v[50:51], v[40:41], v[58:59]
  v_cvt_pk_bf16_f32 v132, v44, v45
  v_cvt_pk_bf16_f32 v136, v48, v49
  v_cvt_pk_bf16_f32 v133, v46, v47
  v_cvt_pk_bf16_f32 v137, v50, v51
  global_load_dwordx4 v[160:163], v141, s[14:15]
  s_add_u32 s14, s14, 57344
  s_addc_u32 s15, s15, 0
  ds_write_b64 v33, v[132:133] offset:2640
  ds_write_b64 v33, v[136:137] offset:10560
  v_pk_mul_f32 v[52:53], v[44:45], v[40:41]
  v_pk_mul_f32 v[56:57], v[48:49], v[40:41]
  v_pk_mul_f32 v[54:55], v[44:45], v[42:43]
  v_pk_mul_f32 v[58:59], v[48:49], v[42:43]
  v_pk_fma_f32 v[44:45], v[46:47], v[42:43], v[52:53] neg_lo:[1,0,0] neg_hi:[1,0,0]
  v_pk_fma_f32 v[48:49], v[50:51], v[42:43], v[56:57] neg_lo:[1,0,0] neg_hi:[1,0,0]
  v_pk_fma_f32 v[46:47], v[46:47], v[40:41], v[54:55]
  v_pk_fma_f32 v[50:51], v[50:51], v[40:41], v[58:59]
  v_cvt_pk_bf16_f32 v128, v44, v45
  v_cvt_pk_bf16_f32 v138, v48, v49
  v_cvt_pk_bf16_f32 v129, v46, v47
  v_cvt_pk_bf16_f32 v139, v50, v51
  ds_write_b64 v33, v[128:129] offset:3168
  global_load_dwordx4 v[164:167], v141, s[14:15]
  s_add_u32 s14, s14, 57344
  s_addc_u32 s15, s15, 0
  ds_write_b64 v33, v[138:139] offset:11088
  v_pk_mul_f32 v[52:53], v[44:45], v[40:41]
  v_pk_mul_f32 v[56:57], v[48:49], v[40:41]
  v_pk_mul_f32 v[54:55], v[44:45], v[42:43]
  v_pk_mul_f32 v[58:59], v[48:49], v[42:43]
  v_pk_fma_f32 v[44:45], v[46:47], v[42:43], v[52:53] neg_lo:[1,0,0] neg_hi:[1,0,0]
  v_pk_fma_f32 v[48:49], v[50:51], v[42:43], v[56:57] neg_lo:[1,0,0] neg_hi:[1,0,0]
  v_pk_fma_f32 v[46:47], v[46:47], v[40:41], v[54:55]
  v_pk_fma_f32 v[50:51], v[50:51], v[40:41], v[58:59]
  v_cvt_pk_bf16_f32 v130, v44, v45
  v_cvt_pk_bf16_f32 v134, v48, v49
  v_cvt_pk_bf16_f32 v131, v46, v47
  v_cvt_pk_bf16_f32 v135, v50, v51
  ds_write_b64 v33, v[130:131] offset:3696
  ds_write_b64 v33, v[134:135] offset:11616
  global_load_dwordx4 v[168:171], v141, s[14:15]
  s_add_u32 s14, s14, 57344
  s_addc_u32 s15, s15, 0
  v_pk_mul_f32 v[52:53], v[44:45], v[40:41]
  v_pk_mul_f32 v[56:57], v[48:49], v[40:41]
  v_pk_mul_f32 v[54:55], v[44:45], v[42:43]
  v_pk_mul_f32 v[58:59], v[48:49], v[42:43]
  v_pk_fma_f32 v[44:45], v[46:47], v[42:43], v[52:53] neg_lo:[1,0,0] neg_hi:[1,0,0]
  v_pk_fma_f32 v[48:49], v[50:51], v[42:43], v[56:57] neg_lo:[1,0,0] neg_hi:[1,0,0]
  v_pk_fma_f32 v[46:47], v[46:47], v[40:41], v[54:55]
  v_pk_fma_f32 v[50:51], v[50:51], v[40:41], v[58:59]
  v_cvt_pk_bf16_f32 v132, v44, v45
  v_cvt_pk_bf16_f32 v136, v48, v49
  v_cvt_pk_bf16_f32 v133, v46, v47
  v_cvt_pk_bf16_f32 v137, v50, v51
  ds_write_b64 v33, v[132:133] offset:4224
  ds_write_b64 v33, v[136:137] offset:12144
  v_pk_mul_f32 v[52:53], v[44:45], v[40:41]
  global_load_dwordx4 v[172:175], v141, s[14:15]
  s_add_u32 s14, s14, 57344
  s_addc_u32 s15, s15, 0
  v_pk_mul_f32 v[56:57], v[48:49], v[40:41]
  v_pk_mul_f32 v[54:55], v[44:45], v[42:43]
  v_pk_mul_f32 v[58:59], v[48:49], v[42:43]
  v_pk_fma_f32 v[44:45], v[46:47], v[42:43], v[52:53] neg_lo:[1,0,0] neg_hi:[1,0,0]
  v_pk_fma_f32 v[48:49], v[50:51], v[42:43], v[56:57] neg_lo:[1,0,0] neg_hi:[1,0,0]
  v_pk_fma_f32 v[46:47], v[46:47], v[40:41], v[54:55]
  v_pk_fma_f32 v[50:51], v[50:51], v[40:41], v[58:59]
  v_cvt_pk_bf16_f32 v128, v44, v45
  v_cvt_pk_bf16_f32 v138, v48, v49
  v_cvt_pk_bf16_f32 v129, v46, v47
  v_cvt_pk_bf16_f32 v139, v50, v51
  ds_write_b64 v33, v[128:129] offset:4752
  ds_write_b64 v33, v[138:139] offset:12672
  v_pk_mul_f32 v[52:53], v[44:45], v[40:41]
  v_pk_mul_f32 v[56:57], v[48:49], v[40:41]
  global_load_dwordx4 v[176:179], v141, s[14:15]
  s_add_u32 s14, s14, 57344
  s_addc_u32 s15, s15, 0
  v_pk_mul_f32 v[54:55], v[44:45], v[42:43]
  v_pk_mul_f32 v[58:59], v[48:49], v[42:43]
  v_pk_fma_f32 v[44:45], v[46:47], v[42:43], v[52:53] neg_lo:[1,0,0] neg_hi:[1,0,0]
  v_pk_fma_f32 v[48:49], v[50:51], v[42:43], v[56:57] neg_lo:[1,0,0] neg_hi:[1,0,0]
  v_pk_fma_f32 v[46:47], v[46:47], v[40:41], v[54:55]
  v_pk_fma_f32 v[50:51], v[50:51], v[40:41], v[58:59]
  v_cvt_pk_bf16_f32 v130, v44, v45
  v_cvt_pk_bf16_f32 v134, v48, v49
  v_cvt_pk_bf16_f32 v131, v46, v47
  v_cvt_pk_bf16_f32 v135, v50, v51
  ds_write_b64 v33, v[130:131] offset:5280
  ds_write_b64 v33, v[134:135] offset:13200
  v_pk_mul_f32 v[52:53], v[44:45], v[40:41]
  v_pk_mul_f32 v[56:57], v[48:49], v[40:41]
  v_pk_mul_f32 v[54:55], v[44:45], v[42:43]
  global_load_dwordx4 v[180:183], v141, s[14:15]
  s_add_u32 s14, s14, 57344
  s_addc_u32 s15, s15, 0
  v_pk_mul_f32 v[58:59], v[48:49], v[42:43]
  v_pk_fma_f32 v[44:45], v[46:47], v[42:43], v[52:53] neg_lo:[1,0,0] neg_hi:[1,0,0]
  v_pk_fma_f32 v[48:49], v[50:51], v[42:43], v[56:57] neg_lo:[1,0,0] neg_hi:[1,0,0]
  v_pk_fma_f32 v[46:47], v[46:47], v[40:41], v[54:55]
  v_pk_fma_f32 v[50:51], v[50:51], v[40:41], v[58:59]
  v_cvt_pk_bf16_f32 v132, v44, v45
  v_cvt_pk_bf16_f32 v136, v48, v49
  v_cvt_pk_bf16_f32 v133, v46, v47
  v_cvt_pk_bf16_f32 v137, v50, v51
  ds_write_b64 v33, v[132:133] offset:5808
  ds_write_b64 v33, v[136:137] offset:13728
  v_pk_mul_f32 v[52:53], v[44:45], v[40:41]
  v_pk_mul_f32 v[56:57], v[48:49], v[40:41]
  v_pk_mul_f32 v[54:55], v[44:45], v[42:43]
  v_pk_mul_f32 v[58:59], v[48:49], v[42:43]
  global_load_dwordx4 v[184:187], v141, s[14:15]
  s_add_u32 s14, s14, 57344
  s_addc_u32 s15, s15, 0
  v_pk_fma_f32 v[44:45], v[46:47], v[42:43], v[52:53] neg_lo:[1,0,0] neg_hi:[1,0,0]
  v_pk_fma_f32 v[48:49], v[50:51], v[42:43], v[56:57] neg_lo:[1,0,0] neg_hi:[1,0,0]
  v_pk_fma_f32 v[46:47], v[46:47], v[40:41], v[54:55]
  v_pk_fma_f32 v[50:51], v[50:51], v[40:41], v[58:59]
  v_cvt_pk_bf16_f32 v128, v44, v45
  v_cvt_pk_bf16_f32 v138, v48, v49
  v_cvt_pk_bf16_f32 v129, v46, v47
  v_cvt_pk_bf16_f32 v139, v50, v51
  ds_write_b64 v33, v[128:129] offset:6336
  ds_write_b64 v33, v[138:139] offset:14256
  v_pk_mul_f32 v[52:53], v[44:45], v[40:41]
  v_pk_mul_f32 v[56:57], v[48:49], v[40:41]
  v_pk_mul_f32 v[54:55], v[44:45], v[42:43]
  v_pk_mul_f32 v[58:59], v[48:49], v[42:43]
  v_pk_fma_f32 v[44:45], v[46:47], v[42:43], v[52:53] neg_lo:[1,0,0] neg_hi:[1,0,0]
  global_load_dwordx4 v[188:191], v141, s[14:15]
  s_add_u32 s14, s14, 57344
  s_addc_u32 s15, s15, 0
  v_pk_fma_f32 v[48:49], v[50:51], v[42:43], v[56:57] neg_lo:[1,0,0] neg_hi:[1,0,0]
  v_pk_fma_f32 v[46:47], v[46:47], v[40:41], v[54:55]
  v_pk_fma_f32 v[50:51], v[50:51], v[40:41], v[58:59]
  v_cvt_pk_bf16_f32 v130, v44, v45
  v_cvt_pk_bf16_f32 v134, v48, v49
  v_cvt_pk_bf16_f32 v131, v46, v47
  v_cvt_pk_bf16_f32 v135, v50, v51
  ds_write_b64 v33, v[130:131] offset:6864
  ds_write_b64 v33, v[134:135] offset:14784
  v_pk_mul_f32 v[52:53], v[44:45], v[40:41]
  v_pk_mul_f32 v[56:57], v[48:49], v[40:41]
  v_pk_mul_f32 v[54:55], v[44:45], v[42:43]
  v_pk_mul_f32 v[58:59], v[48:49], v[42:43]
  v_pk_fma_f32 v[44:45], v[46:47], v[42:43], v[52:53] neg_lo:[1,0,0] neg_hi:[1,0,0]
  v_pk_fma_f32 v[48:49], v[50:51], v[42:43], v[56:57] neg_lo:[1,0,0] neg_hi:[1,0,0]
  global_load_dwordx4 v[192:195], v141, s[14:15]
  s_add_u32 s14, s14, 57344
  s_addc_u32 s15, s15, 0
  v_pk_fma_f32 v[46:47], v[46:47], v[40:41], v[54:55]
  v_pk_fma_f32 v[50:51], v[50:51], v[40:41], v[58:59]
  v_cvt_pk_bf16_f32 v132, v44, v45
  v_cvt_pk_bf16_f32 v136, v48, v49
  v_cvt_pk_bf16_f32 v133, v46, v47
  v_cvt_pk_bf16_f32 v137, v50, v51
  ds_write_b64 v33, v[132:133] offset:7392
  ds_write_b64 v33, v[136:137] offset:15312
  v_pk_mul_f32 v[52:53], v[44:45], v[40:41]
  v_pk_mul_f32 v[56:57], v[48:49], v[40:41]
  v_pk_mul_f32 v[54:55], v[44:45], v[42:43]
  v_pk_mul_f32 v[58:59], v[48:49], v[42:43]
  v_pk_fma_f32 v[44:45], v[46:47], v[42:43], v[52:53] neg_lo:[1,0,0] neg_hi:[1,0,0]
  v_pk_fma_f32 v[48:49], v[50:51], v[42:43], v[56:57] neg_lo:[1,0,0] neg_hi:[1,0,0]
  v_pk_fma_f32 v[46:47], v[46:47], v[40:41], v[54:55]
  global_load_dwordx4 v[196:199], v141, s[14:15]
  s_add_u32 s14, s14, 57344
  s_addc_u32 s15, s15, 0
  s_sub_u32 s14, s14, s3
  s_subb_u32 s15, s15, 0
  v_pk_fma_f32 v[50:51], v[50:51], v[40:41], v[58:59]
  v_cvt_pk_bf16_f32 v128, v44, v45
  v_cvt_pk_bf16_f32 v138, v48, v49
  v_cvt_pk_bf16_f32 v129, v46, v47
  v_cvt_pk_bf16_f32 v139, v50, v51
  ds_write_b64 v33, v[128:129] offset:7920
  ds_write_b64 v33, v[138:139] offset:15840
  v_pk_mul_f32 v[56:57], v[48:49], v[40:41]
  v_pk_mul_f32 v[58:59], v[48:49], v[42:43]
  v_pk_fma_f32 v[48:49], v[50:51], v[42:43], v[56:57] neg_lo:[1,0,0] neg_hi:[1,0,0]
  v_pk_fma_f32 v[50:51], v[50:51], v[40:41], v[58:59]
  v_cvt_pk_bf16_f32 v134, v48, v49
  v_cvt_pk_bf16_f32 v135, v50, v51
  ds_write_b64 v33, v[134:135] offset:16368
  v_and_b32 v11, 31, v1
  v_lshrrev_b32 v12, 5, v1
  v_mul_u32_u24 v13, 528, v11
  v_lshl_add_u32 v13, v12, 4, v13
  v_add_u32 v13, s54, v13
  v_lshlrev_b32 v12, 9, v12
  v_lshl_add_u32 v12, v11, 2, v12
  v_add_u32 v12, s54, v12
  s_waitcnt lgkmcnt(0)
  s_barrier
  ds_read_b128 v[80:83], v13 offset:16896
  ds_read_b128 v[84:87], v13 offset:0
  ds_read_b128 v[88:91], v13 offset:16928
  s_waitcnt vmcnt(14)
  ds_read_b128 v[92:95], v13 offset:32
  s_waitcnt vmcnt(14)
  ds_read_b128 v[96:99], v13 offset:16960
  ds_read_b128 v[100:103], v13 offset:64
  ds_read_b128 v[104:107], v13 offset:16992
  ds_read_b128 v[108:111], v13 offset:96
  ds_read_b128 v[112:115], v13 offset:17024
  ds_read_b128 v[116:119], v13 offset:128
  ds_read_b128 v[120:123], v13 offset:17056
  ds_read_b128 v[124:127], v13 offset:160
  s_waitcnt lgkmcnt(10)
  v_mfma_f32_32x32x16_bf16 v[64:79], v[80:83], v[84:87], 0
  ds_read_b128 v[80:83], v13 offset:17088
  ds_read_b128 v[84:87], v13 offset:192
  s_waitcnt lgkmcnt(10)
  v_mfma_f32_32x32x16_bf16 v[64:79], v[88:91], v[92:95], v[64:79]
  ds_read_b128 v[88:91], v13 offset:17120
  ds_read_b128 v[92:95], v13 offset:224
  s_waitcnt lgkmcnt(10)
  v_mfma_f32_32x32x16_bf16 v[64:79], v[96:99], v[100:103], v[64:79]
  ds_read_b128 v[96:99], v13 offset:17152
  ds_read_b128 v[100:103], v13 offset:256
  s_waitcnt lgkmcnt(10)
  v_mfma_f32_32x32x16_bf16 v[64:79], v[104:107], v[108:111], v[64:79]
  ds_read_b128 v[104:107], v13 offset:17184
  ds_read_b128 v[108:111], v13 offset:288
  s_waitcnt lgkmcnt(10)
  v_mfma_f32_32x32x16_bf16 v[64:79], v[112:115], v[116:119], v[64:79]
  ds_read_b128 v[112:115], v13 offset:17216
  ds_read_b128 v[116:119], v13 offset:320
  s_waitcnt lgkmcnt(10)
  v_mfma_f32_32x32x16_bf16 v[64:79], v[120:123], v[124:127], v[64:79]
  ds_read_b128 v[120:123], v13 offset:17248
  ds_read_b128 v[124:127], v13 offset:352
  s_waitcnt lgkmcnt(10)
  v_mfma_f32_32x32x16_bf16 v[64:79], v[80:83], v[84:87], v[64:79]
  ds_read_b128 v[80:83], v13 offset:17280
  ds_read_b128 v[84:87], v13 offset:384
  s_waitcnt lgkmcnt(10)
  v_mfma_f32_32x32x16_bf16 v[64:79], v[88:91], v[92:95], v[64:79]
  ds_read_b128 v[88:91], v13 offset:17312
  ds_read_b128 v[92:95], v13 offset:416
  s_waitcnt lgkmcnt(10)
  v_mfma_f32_32x32x16_bf16 v[64:79], v[96:99], v[100:103], v[64:79]
  ds_read_b128 v[96:99], v13 offset:17344
  ds_read_b128 v[100:103], v13 offset:448
  s_waitcnt lgkmcnt(10)
  v_mfma_f32_32x32x16_bf16 v[64:79], v[104:107], v[108:111], v[64:79]
  ds_read_b128 v[104:107], v13 offset:17376
  ds_read_b128 v[108:111], v13 offset:480
  s_waitcnt lgkmcnt(10)
  v_mfma_f32_32x32x16_bf16 v[64:79], v[112:115], v[116:119], v[64:79]
  s_waitcnt lgkmcnt(8)
  v_mfma_f32_32x32x16_bf16 v[64:79], v[120:123], v[124:127], v[64:79]
  s_waitcnt lgkmcnt(6)
  v_mfma_f32_32x32x16_bf16 v[64:79], v[80:83], v[84:87], v[64:79]
  s_waitcnt lgkmcnt(4)
  v_mfma_f32_32x32x16_bf16 v[64:79], v[88:91], v[92:95], v[64:79]
  s_waitcnt lgkmcnt(2)
  v_mfma_f32_32x32x16_bf16 v[64:79], v[96:99], v[100:103], v[64:79]
  s_waitcnt lgkmcnt(0)
  v_mfma_f32_32x32x16_bf16 v[64:79], v[104:107], v[108:111], v[64:79]
  s_nop 11
  ds_write_b32 v12, v64 offset:0
  ds_write_b32 v12, v65 offset:128
  ds_write_b32 v12, v66 offset:256
  ds_write_b32 v12, v67 offset:384
  ds_write_b32 v12, v68 offset:1024
  ds_write_b32 v12, v69 offset:1280
  ds_write_b32 v12, v70 offset:2048
  ds_write_b32 v12, v71 offset:3072
  ds_write_b32 v12, v72 offset:4096
  ds_write_b32 v12, v73 offset:5120
  ds_write_b32 v12, v74 offset:6144
  ds_write_b32 v12, v75 offset:7168
  ds_write_b32 v12, v76 offset:8192
  s_waitcnt lgkmcnt(0)
  s_barrier
  ds_read2st64_b32 v[12:13], v2 offset0:0 offset1:118
  ds_read2st64_b32 v[14:15], v3 offset0:0 offset1:118
  ds_read2st64_b32 v[16:17], v4 offset0:0 offset1:118
  ds_read2st64_b32 v[18:19], v5 offset0:0 offset1:118
  ds_read2st64_b32 v[20:21], v6 offset0:0 offset1:118
  ds_read2st64_b32 v[22:23], v7 offset0:0 offset1:118
  ds_read2st64_b32 v[24:25], v8 offset0:0 offset1:118
  ds_read2st64_b32 v[26:27], v9 offset0:0 offset1:118
  ds_read2st64_b32 v[28:29], v10 offset0:0 offset1:118
  v_and_b32 v11, 255, v0
  s_lshr_b32 s42, s35, 2
  s_mul_i32 s42, s42, 8320
  s_add_u32 s42, s42, 120832
  v_cmp_ne_u32 vcc, 255, v11
  v_lshl_add_u32 v11, v11, 4, s42
  s_waitcnt lgkmcnt(8)
  v_add_f32 v12, v12, v13
  s_waitcnt lgkmcnt(7)
  v_add_f32 v14, v14, v15
  s_waitcnt lgkmcnt(6)
  v_add_f32 v16, v16, v17
  s_waitcnt lgkmcnt(5)
  v_add_f32 v18, v18, v19
  s_waitcnt lgkmcnt(4)
  v_add_f32 v20, v20, v21
  s_waitcnt lgkmcnt(3)
  v_add_f32 v22, v22, v23
  s_waitcnt lgkmcnt(2)
  v_add_f32 v24, v24, v25
  s_waitcnt lgkmcnt(1)
  v_add_f32 v26, v26, v27
  s_waitcnt lgkmcnt(0)
  v_add_f32 v28, v28, v29
  v_cndmask_b32 v28, 0, v28, vcc
  v_cvt_pk_bf16_f32 v4, v12, v14
  v_cvt_pk_bf16_f32 v5, v16, v18
  v_cvt_pk_bf16_f32 v6, v20, v22
  v_cvt_pk_bf16_f32 v7, v24, v26
  ds_write_b128 v11, v[4:7]
  v_cvt_pk_bf16_f32 v32, v14, v16
  v_cvt_pk_bf16_f32 v33, v18, v20
  v_cvt_pk_bf16_f32 v34, v22, v24
  v_cvt_pk_bf16_f32 v35, v26, v28
  ds_write_b128 v11, v[32:35] offset:4160
  global_load_dwordx4 v[200:203], v141, s[14:15]
  s_add_u32 s14, s14, 57344
  s_addc_u32 s15, s15, 0
  global_load_dwordx4 v[204:207], v141, s[14:15]
  s_add_u32 s14, s14, 57344
  s_addc_u32 s15, s15, 0
  global_load_dwordx4 v[208:211], v141, s[14:15]
  s_add_u32 s14, s14, 57344
  s_addc_u32 s15, s15, 0
  global_load_dwordx4 v[212:215], v141, s[14:15]
  s_add_u32 s14, s14, 57344
  s_addc_u32 s15, s15, 0
  global_load_dwordx4 v[216:219], v141, s[14:15]
  s_add_u32 s14, s14, 57344
  s_addc_u32 s15, s15, 0
  global_load_dwordx4 v[220:223], v141, s[14:15]
  s_add_u32 s14, s14, 57344
  s_addc_u32 s15, s15, 0
  global_load_dwordx4 v[224:227], v141, s[14:15]
  s_add_u32 s14, s14, 57344
  s_addc_u32 s15, s15, 0
  global_load_dwordx4 v[228:231], v141, s[14:15]
  s_add_u32 s14, s14, 57344
  s_addc_u32 s15, s15, 0
  global_load_dwordx4 v[232:235], v141, s[14:15]
  s_add_u32 s14, s14, 57344
  s_addc_u32 s15, s15, 0
  global_load_dwordx4 v[236:239], v141, s[14:15]
  s_add_u32 s14, s14, 57344
  s_addc_u32 s15, s15, 0
  global_load_dwordx4 v[240:243], v141, s[14:15]
  s_add_u32 s14, s14, 57344
  s_addc_u32 s15, s15, 0
  global_load_dwordx4 v[244:247], v141, s[14:15]
  s_add_u32 s14, s14, 57344
  s_addc_u32 s15, s15, 0
  global_load_dwordx4 v[248:251], v141, s[14:15]
  s_add_u32 s14, s14, 57344
  s_addc_u32 s15, s15, 0
  global_load_dwordx4 v[252:255], v141, s[14:15]
  s_add_u32 s14, s14, 57344
  s_addc_u32 s15, s15, 0
  v_and_b32 v11, 15, v1
  v_lshrrev_b32 v12, 4, v1
  s_lshr_b32 s42, s35, 1
  s_and_b32 s43, s35, 1
  s_mul_i32 s48, s42, 8320
  s_lshl_b32 s49, s43, 8
  s_sub_u32 s48, s48, s49
  s_add_u32 s48, s48, 124190
  v_lshlrev_b32 v13, 3, v12
  v_sub_u32 v13, v13, v11
  v_and_b32 v14, 1, v11
  v_mul_u32_u24 v14, 4158, v14
  v_lshl_add_u32 v13, v13, 1, s48
  v_add_u32 v13, 4158, v13
  v_sub_u32 v2, v13, v14
  v_subrev_u32 v3, 1024, v2
  v_subrev_u32 v4, 2048, v2
  v_subrev_u32 v5, 3072, v2
  s_mul_i32 s48, s42, 4576
  s_sub_u32 s48, s48, s49
  s_add_u32 s48, s48, 137728
  v_lshlrev_b32 v6, 5, v11
  v_lshl_add_u32 v6, v12, 4, v6
  v_add_u32 v6, s48, v6
  s_mul_i32 s48, s35, 10240
  v_mul_u32_u24 v7, 320, v12
  v_lshl_add_u32 v7, v11, 4, v7
  v_add_u32 v7, s48, v7
  v_and_b32 v38, 3, v1
  v_mul_u32_u24 v38, 320, v38
  v_lshrrev_b32 v37, 2, v1
  v_lshl_add_u32 v37, v37, 4, v38
  s_mul_i32 s43, s35, 1280
  v_add_u32 v37, s43, v37
  v_lshlrev_b32 v36, 4, v0
  s_lshl_b32 s42, s37, 13
  s_add_u32 s42, s42, 8388608
  s_add_u32 s18, s32, s42
  s_addc_u32 s19, s33, 0
  v_lshrrev_b32 v140, 5, v1
  v_bfe_u32 v141, v1, 2, 2
  v_lshl_add_u32 v140, v140, 3, v141
  v_bfe_u32 v141, v1, 4, 1
  v_lshlrev_b32 v140, 6, v140
  v_lshl_add_u32 v140, v141, 5, v140
  v_and_b32 v141, 3, v1
  v_lshl_add_u32 v140, v141, 3, v140
  s_lshl_b32 s42, s35, 10
  s_add_u32 s42, s42, 146688
  v_add_u32 v140, s42, v140
  v_lshlrev_b32 v141, 4, v0
  v_add_u32 v141, 146688, v141
  s_waitcnt vmcnt(27)
  ds_write_b128 v141, v[144:147]
  ds_read_b64_tr_b16 v[144:145], v140 offset:0
  ds_read_b64_tr_b16 v[146:147], v140 offset:256
  s_waitcnt vmcnt(26)
  ds_write_b128 v141, v[148:151]
  ds_read_b64_tr_b16 v[148:149], v140 offset:0
  ds_read_b64_tr_b16 v[150:151], v140 offset:256
  s_waitcnt vmcnt(25)
  ds_write_b128 v141, v[152:155]
  ds_read_b64_tr_b16 v[152:153], v140 offset:0
  ds_read_b64_tr_b16 v[154:155], v140 offset:256
  s_waitcnt vmcnt(24)
  ds_write_b128 v141, v[156:159]
  ds_read_b64_tr_b16 v[156:157], v140 offset:0
  ds_read_b64_tr_b16 v[158:159], v140 offset:256
  s_waitcnt vmcnt(23)
  ds_write_b128 v141, v[160:163]
  ds_read_b64_tr_b16 v[160:161], v140 offset:0
  ds_read_b64_tr_b16 v[162:163], v140 offset:256
  s_waitcnt vmcnt(22)
  ds_write_b128 v141, v[164:167]
  ds_read_b64_tr_b16 v[164:165], v140 offset:0
  ds_read_b64_tr_b16 v[166:167], v140 offset:256
  s_waitcnt lgkmcnt(0)
  s_barrier
  ds_read2_b32 v[16:17], v2 offset0:176 offset1:177
  ds_read2_b32 v[18:19], v2 offset0:178 offset1:179
  ds_read_b128 v[96:99], v6 offset:192
  ds_read_b128 v[100:103], v6 offset:704
  ds_read_b128 v[104:107], v6 offset:1216
  ds_read_b128 v[108:111], v6 offset:1728
  ds_read_b128 v[112:115], v6 offset:2240
  ds_read_b128 v[116:119], v6 offset:2752
  ds_read_b128 v[120:123], v6 offset:3264
  ds_read_b128 v[124:127], v6 offset:3776
  s_waitcnt lgkmcnt(7)
  v_mfma_f32_16x16x32_bf16 v[64:67], v[16:19], v[96:99], 0
  ds_read2_b32 v[20:21], v2 offset0:48 offset1:49
  ds_read2_b32 v[22:23], v2 offset0:50 offset1:51
  ds_read_b128 v[128:131], v6 offset:128
  s_waitcnt lgkmcnt(9)
  v_mfma_f32_16x16x32_bf16 v[68:71], v[16:19], v[100:103], 0
  ds_read2_b32 v[24:25], v3 offset0:176 offset1:177
  ds_read2_b32 v[26:27], v3 offset0:178 offset1:179
  ds_read_b128 v[132:135], v6 offset:640
  s_waitcnt lgkmcnt(11)
  v_mfma_f32_16x16x32_bf16 v[72:75], v[16:19], v[104:107], 0
  ds_read2_b32 v[28:29], v3 offset0:48 offset1:49
  ds_read2_b32 v[30:31], v3 offset0:50 offset1:51
  s_waitcnt lgkmcnt(12)
  v_mfma_f32_16x16x32_bf16 v[76:79], v[16:19], v[108:111], 0
  ds_read2_b32 v[32:33], v4 offset0:176 offset1:177
  ds_read2_b32 v[34:35], v4 offset0:178 offset1:179
  s_waitcnt lgkmcnt(13)
  v_mfma_f32_16x16x32_bf16 v[80:83], v[16:19], v[112:115], 0
  s_waitcnt lgkmcnt(12)
  v_mfma_f32_16x16x32_bf16 v[84:87], v[16:19], v[116:119], 0
  s_waitcnt lgkmcnt(11)
  v_mfma_f32_16x16x32_bf16 v[88:91], v[16:19], v[120:123], 0
  s_waitcnt lgkmcnt(10)
  v_mfma_f32_16x16x32_bf16 v[92:95], v[16:19], v[124:127], 0
  ds_read2_b32 v[16:17], v4 offset0:48 offset1:49
  ds_read2_b32 v[18:19], v4 offset0:50 offset1:51
  ds_read_b128 v[124:127], v6 offset:1152
  s_waitcnt lgkmcnt(11)
  v_mfma_f32_16x16x32_bf16 v[68:71], v[20:23], v[96:99], v[68:71]
  v_mfma_f32_16x16x32_bf16 v[72:75], v[20:23], v[100:103], v[72:75]
  v_mfma_f32_16x16x32_bf16 v[76:79], v[20:23], v[104:107], v[76:79]
  v_mfma_f32_16x16x32_bf16 v[80:83], v[20:23], v[108:111], v[80:83]
  v_mfma_f32_16x16x32_bf16 v[84:87], v[20:23], v[112:115], v[84:87]
  v_mfma_f32_16x16x32_bf16 v[88:91], v[20:23], v[116:119], v[88:91]
  v_mfma_f32_16x16x32_bf16 v[92:95], v[20:23], v[120:123], v[92:95]
  ds_read2_b32 v[20:21], v5 offset0:176 offset1:177
  ds_read2_b32 v[22:23], v5 offset0:178 offset1:179
  ds_read_b128 v[120:123], v6 offset:1664
  s_waitcnt lgkmcnt(11)
  v_mfma_f32_16x16x32_bf16 v[72:75], v[24:27], v[96:99], v[72:75]
  v_mfma_f32_16x16x32_bf16 v[76:79], v[24:27], v[100:103], v[76:79]
  v_mfma_f32_16x16x32_bf16 v[80:83], v[24:27], v[104:107], v[80:83]
  v_mfma_f32_16x16x32_bf16 v[84:87], v[24:27], v[108:111], v[84:87]
  v_mfma_f32_16x16x32_bf16 v[88:91], v[24:27], v[112:115], v[88:91]
  v_mfma_f32_16x16x32_bf16 v[92:95], v[24:27], v[116:119], v[92:95]
  ds_read2_b32 v[24:25], v5 offset0:48 offset1:49
  ds_read2_b32 v[26:27], v5 offset0:50 offset1:51
  ds_read_b128 v[116:119], v6 offset:2176
  s_waitcnt lgkmcnt(11)
  v_mfma_f32_16x16x32_bf16 v[76:79], v[28:31], v[96:99], v[76:79]
  v_mfma_f32_16x16x32_bf16 v[80:83], v[28:31], v[100:103], v[80:83]
  v_mfma_f32_16x16x32_bf16 v[84:87], v[28:31], v[104:107], v[84:87]
  v_mfma_f32_16x16x32_bf16 v[88:91], v[28:31], v[108:111], v[88:91]
  v_mfma_f32_16x16x32_bf16 v[92:95], v[28:31], v[112:115], v[92:95]
  ds_read2_b32 v[28:29], v2 offset0:160 offset1:161
  ds_read2_b32 v[30:31], v2 offset0:162 offset1:163
  ds_read_b128 v[112:115], v6 offset:2688
  s_waitcnt lgkmcnt(12)
  v_mfma_f32_16x16x32_bf16 v[80:83], v[32:35], v[96:99], v[80:83]
  v_mfma_f32_16x16x32_bf16 v[84:87], v[32:35], v[100:103], v[84:87]
  v_mfma_f32_16x16x32_bf16 v[88:91], v[32:35], v[104:107], v[88:91]
  v_mfma_f32_16x16x32_bf16 v[92:95], v[32:35], v[108:111], v[92:95]
  ds_read2_b32 v[32:33], v2 offset0:32 offset1:33
  ds_read2_b32 v[34:35], v2 offset0:34 offset1:35
  ds_read_b128 v[108:111], v6 offset:3200
  s_waitcnt lgkmcnt(13)
  v_mfma_f32_16x16x32_bf16 v[84:87], v[16:19], v[96:99], v[84:87]
  v_mfma_f32_16x16x32_bf16 v[88:91], v[16:19], v[100:103], v[88:91]
  v_mfma_f32_16x16x32_bf16 v[92:95], v[16:19], v[104:107], v[92:95]
  ds_read2_b32 v[16:17], v3 offset0:160 offset1:161
  ds_read2_b32 v[18:19], v3 offset0:162 offset1:163
  ds_read_b128 v[104:107], v6 offset:3712
  s_waitcnt lgkmcnt(13)
  v_mfma_f32_16x16x32_bf16 v[88:91], v[20:23], v[96:99], v[88:91]
  v_mfma_f32_16x16x32_bf16 v[92:95], v[20:23], v[100:103], v[92:95]
  ds_read2_b32 v[20:21], v3 offset0:32 offset1:33
  ds_read2_b32 v[22:23], v3 offset0:34 offset1:35
  ds_read_b128 v[100:103], v6 offset:64
  s_waitcnt lgkmcnt(13)
  v_mfma_f32_16x16x32_bf16 v[92:95], v[24:27], v[96:99], v[92:95]
  ds_read2_b32 v[24:25], v4 offset0:160 offset1:161
  ds_read2_b32 v[26:27], v4 offset0:162 offset1:163
  ds_read_b128 v[96:99], v6 offset:576
  s_waitcnt lgkmcnt(13)
  v_mfma_f32_16x16x32_bf16 v[64:67], v[28:31], v[128:131], v[64:67]
  v_mfma_f32_16x16x32_bf16 v[68:71], v[28:31], v[132:135], v[68:71]
  v_mfma_f32_16x16x32_bf16 v[72:75], v[28:31], v[124:127], v[72:75]
  v_mfma_f32_16x16x32_bf16 v[76:79], v[28:31], v[120:123], v[76:79]
  v_mfma_f32_16x16x32_bf16 v[80:83], v[28:31], v[116:119], v[80:83]
  s_waitcnt lgkmcnt(12)
  v_mfma_f32_16x16x32_bf16 v[84:87], v[28:31], v[112:115], v[84:87]
  s_waitcnt lgkmcnt(9)
  v_mfma_f32_16x16x32_bf16 v[88:91], v[28:31], v[108:111], v[88:91]
  s_waitcnt lgkmcnt(6)
  v_mfma_f32_16x16x32_bf16 v[92:95], v[28:31], v[104:107], v[92:95]
  ds_read2_b32 v[28:29], v4 offset0:32 offset1:33
  ds_read2_b32 v[30:31], v4 offset0:34 offset1:35
  ds_read_b128 v[104:107], v6 offset:1088
  v_mfma_f32_16x16x32_bf16 v[68:71], v[32:35], v[128:131], v[68:71]
  v_mfma_f32_16x16x32_bf16 v[72:75], v[32:35], v[132:135], v[72:75]
  v_mfma_f32_16x16x32_bf16 v[76:79], v[32:35], v[124:127], v[76:79]
  v_mfma_f32_16x16x32_bf16 v[80:83], v[32:35], v[120:123], v[80:83]
  v_mfma_f32_16x16x32_bf16 v[84:87], v[32:35], v[116:119], v[84:87]
  v_mfma_f32_16x16x32_bf16 v[88:91], v[32:35], v[112:115], v[88:91]
  v_mfma_f32_16x16x32_bf16 v[92:95], v[32:35], v[108:111], v[92:95]
  ds_read2_b32 v[32:33], v5 offset0:160 offset1:161
  ds_read2_b32 v[34:35], v5 offset0:162 offset1:163
  ds_read_b128 v[108:111], v6 offset:1600
  v_mfma_f32_16x16x32_bf16 v[72:75], v[16:19], v[128:131], v[72:75]
  v_mfma_f32_16x16x32_bf16 v[76:79], v[16:19], v[132:135], v[76:79]
  v_mfma_f32_16x16x32_bf16 v[80:83], v[16:19], v[124:127], v[80:83]
  v_mfma_f32_16x16x32_bf16 v[84:87], v[16:19], v[120:123], v[84:87]
  v_mfma_f32_16x16x32_bf16 v[88:91], v[16:19], v[116:119], v[88:91]
  v_mfma_f32_16x16x32_bf16 v[92:95], v[16:19], v[112:115], v[92:95]
  ds_read2_b32 v[16:17], v5 offset0:32 offset1:33
  ds_read2_b32 v[18:19], v5 offset0:34 offset1:35
  ds_read_b128 v[112:115], v6 offset:2112
  s_waitcnt lgkmcnt(13)
  v_mfma_f32_16x16x32_bf16 v[76:79], v[20:23], v[128:131], v[76:79]
  v_mfma_f32_16x16x32_bf16 v[80:83], v[20:23], v[132:135], v[80:83]
  v_mfma_f32_16x16x32_bf16 v[84:87], v[20:23], v[124:127], v[84:87]
  v_mfma_f32_16x16x32_bf16 v[88:91], v[20:23], v[120:123], v[88:91]
  v_mfma_f32_16x16x32_bf16 v[92:95], v[20:23], v[116:119], v[92:95]
  ds_read2_b32 v[20:21], v2 offset0:144 offset1:145
  ds_read2_b32 v[22:23], v2 offset0:146 offset1:147
  ds_read_b128 v[116:119], v6 offset:2624
  s_waitcnt lgkmcnt(13)
  v_mfma_f32_16x16x32_bf16 v[80:83], v[24:27], v[128:131], v[80:83]
  v_mfma_f32_16x16x32_bf16 v[84:87], v[24:27], v[132:135], v[84:87]
  v_mfma_f32_16x16x32_bf16 v[88:91], v[24:27], v[124:127], v[88:91]
  v_mfma_f32_16x16x32_bf16 v[92:95], v[24:27], v[120:123], v[92:95]
  ds_read2_b32 v[24:25], v2 offset0:16 offset1:17
  ds_read2_b32 v[26:27], v2 offset0:18 offset1:19
  ds_read_b128 v[120:123], v6 offset:3136
  s_waitcnt lgkmcnt(13)
  v_mfma_f32_16x16x32_bf16 v[84:87], v[28:31], v[128:131], v[84:87]
  v_mfma_f32_16x16x32_bf16 v[88:91], v[28:31], v[132:135], v[88:91]
  v_mfma_f32_16x16x32_bf16 v[92:95], v[28:31], v[124:127], v[92:95]
  ds_read2_b32 v[28:29], v3 offset0:144 offset1:145
  ds_read2_b32 v[30:31], v3 offset0:146 offset1:147
  ds_read_b128 v[124:127], v6 offset:3648
  s_waitcnt lgkmcnt(13)
  v_mfma_f32_16x16x32_bf16 v[88:91], v[32:35], v[128:131], v[88:91]
  v_mfma_f32_16x16x32_bf16 v[92:95], v[32:35], v[132:135], v[92:95]
  ds_read2_b32 v[32:33], v3 offset0:16 offset1:17
  ds_read2_b32 v[34:35], v3 offset0:18 offset1:19
  ds_read_b128 v[132:135], v6 offset:0
  s_waitcnt lgkmcnt(13)
  v_mfma_f32_16x16x32_bf16 v[92:95], v[16:19], v[128:131], v[92:95]
  ds_read2_b32 v[16:17], v4 offset0:144 offset1:145
  ds_read2_b32 v[18:19], v4 offset0:146 offset1:147
  ds_read_b128 v[128:131], v6 offset:512
  s_waitcnt lgkmcnt(13)
  v_mfma_f32_16x16x32_bf16 v[64:67], v[20:23], v[100:103], v[64:67]
  v_mfma_f32_16x16x32_bf16 v[68:71], v[20:23], v[96:99], v[68:71]
  v_mfma_f32_16x16x32_bf16 v[72:75], v[20:23], v[104:107], v[72:75]
  v_mfma_f32_16x16x32_bf16 v[76:79], v[20:23], v[108:111], v[76:79]
  v_mfma_f32_16x16x32_bf16 v[80:83], v[20:23], v[112:115], v[80:83]
  s_waitcnt lgkmcnt(12)
  v_mfma_f32_16x16x32_bf16 v[84:87], v[20:23], v[116:119], v[84:87]
  s_waitcnt lgkmcnt(9)
  v_mfma_f32_16x16x32_bf16 v[88:91], v[20:23], v[120:123], v[88:91]
  s_waitcnt lgkmcnt(6)
  v_mfma_f32_16x16x32_bf16 v[92:95], v[20:23], v[124:127], v[92:95]
  ds_read2_b32 v[20:21], v4 offset0:16 offset1:17
  ds_read2_b32 v[22:23], v4 offset0:18 offset1:19
  ds_read_b128 v[124:127], v6 offset:1024
  v_mfma_f32_16x16x32_bf16 v[68:71], v[24:27], v[100:103], v[68:71]
  v_mfma_f32_16x16x32_bf16 v[72:75], v[24:27], v[96:99], v[72:75]
  v_mfma_f32_16x16x32_bf16 v[76:79], v[24:27], v[104:107], v[76:79]
  v_mfma_f32_16x16x32_bf16 v[80:83], v[24:27], v[108:111], v[80:83]
  v_mfma_f32_16x16x32_bf16 v[84:87], v[24:27], v[112:115], v[84:87]
  v_mfma_f32_16x16x32_bf16 v[88:91], v[24:27], v[116:119], v[88:91]
  v_mfma_f32_16x16x32_bf16 v[92:95], v[24:27], v[120:123], v[92:95]
  ds_read2_b32 v[24:25], v5 offset0:144 offset1:145
  ds_read2_b32 v[26:27], v5 offset0:146 offset1:147
  ds_read_b128 v[120:123], v6 offset:1536
  v_mfma_f32_16x16x32_bf16 v[72:75], v[28:31], v[100:103], v[72:75]
  v_mfma_f32_16x16x32_bf16 v[76:79], v[28:31], v[96:99], v[76:79]
  v_mfma_f32_16x16x32_bf16 v[80:83], v[28:31], v[104:107], v[80:83]
  v_mfma_f32_16x16x32_bf16 v[84:87], v[28:31], v[108:111], v[84:87]
  v_mfma_f32_16x16x32_bf16 v[88:91], v[28:31], v[112:115], v[88:91]
  v_mfma_f32_16x16x32_bf16 v[92:95], v[28:31], v[116:119], v[92:95]
  ds_read2_b32 v[28:29], v5 offset0:16 offset1:17
  ds_read2_b32 v[30:31], v5 offset0:18 offset1:19
  ds_read_b128 v[116:119], v6 offset:2048
  s_waitcnt lgkmcnt(13)
  v_mfma_f32_16x16x32_bf16 v[76:79], v[32:35], v[100:103], v[76:79]
  v_mfma_f32_16x16x32_bf16 v[80:83], v[32:35], v[96:99], v[80:83]
  v_mfma_f32_16x16x32_bf16 v[84:87], v[32:35], v[104:107], v[84:87]
  v_mfma_f32_16x16x32_bf16 v[88:91], v[32:35], v[108:111], v[88:91]
  v_mfma_f32_16x16x32_bf16 v[92:95], v[32:35], v[112:115], v[92:95]
  ds_read2_b32 v[32:33], v2 offset0:128 offset1:129
  ds_read2_b32 v[34:35], v2 offset0:130 offset1:131
  ds_read_b128 v[112:115], v6 offset:2560
  s_waitcnt lgkmcnt(13)
  v_mfma_f32_16x16x32_bf16 v[80:83], v[16:19], v[100:103], v[80:83]
  v_mfma_f32_16x16x32_bf16 v[84:87], v[16:19], v[96:99], v[84:87]
  v_mfma_f32_16x16x32_bf16 v[88:91], v[16:19], v[104:107], v[88:91]
  v_mfma_f32_16x16x32_bf16 v[92:95], v[16:19], v[108:111], v[92:95]
  ds_read2_b32 v[16:17], v2 offset0:0 offset1:1
  ds_read2_b32 v[18:19], v2 offset0:2 offset1:3
  ds_read_b128 v[108:111], v6 offset:3072
  s_waitcnt lgkmcnt(13)
  v_mfma_f32_16x16x32_bf16 v[84:87], v[20:23], v[100:103], v[84:87]
  v_mfma_f32_16x16x32_bf16 v[88:91], v[20:23], v[96:99], v[88:91]
  v_mfma_f32_16x16x32_bf16 v[92:95], v[20:23], v[104:107], v[92:95]
  ds_read2_b32 v[20:21], v3 offset0:128 offset1:129
  ds_read2_b32 v[22:23], v3 offset0:130 offset1:131
  ds_read_b128 v[104:107], v6 offset:3584
  s_waitcnt lgkmcnt(13)
  v_mfma_f32_16x16x32_bf16 v[88:91], v[24:27], v[100:103], v[88:91]
  v_mfma_f32_16x16x32_bf16 v[92:95], v[24:27], v[96:99], v[92:95]
  ds_read2_b32 v[24:25], v3 offset0:0 offset1:1
  ds_read2_b32 v[26:27], v3 offset0:2 offset1:3
  s_waitcnt lgkmcnt(12)
  v_mfma_f32_16x16x32_bf16 v[92:95], v[28:31], v[100:103], v[92:95]
  ds_read2_b32 v[28:29], v4 offset0:128 offset1:129
  ds_read2_b32 v[30:31], v4 offset0:130 offset1:131
  s_waitcnt lgkmcnt(11)
  v_mfma_f32_16x16x32_bf16 v[64:67], v[32:35], v[132:135], v[64:67]
  v_mfma_f32_16x16x32_bf16 v[68:71], v[32:35], v[128:131], v[68:71]
  v_mfma_f32_16x16x32_bf16 v[72:75], v[32:35], v[124:127], v[72:75]
  v_mfma_f32_16x16x32_bf16 v[76:79], v[32:35], v[120:123], v[76:79]
  v_mfma_f32_16x16x32_bf16 v[80:83], v[32:35], v[116:119], v[80:83]
  s_waitcnt lgkmcnt(10)
  v_mfma_f32_16x16x32_bf16 v[84:87], v[32:35], v[112:115], v[84:87]
  s_waitcnt lgkmcnt(7)
  v_mfma_f32_16x16x32_bf16 v[88:91], v[32:35], v[108:111], v[88:91]
  ds_write_b128 v7, v[64:67] offset:0
  s_waitcnt lgkmcnt(5)
  v_mfma_f32_16x16x32_bf16 v[92:95], v[32:35], v[104:107], v[92:95]
  ds_read2_b32 v[32:33], v4 offset0:0 offset1:1
  ds_read2_b32 v[34:35], v4 offset0:2 offset1:3
  v_mfma_f32_16x16x32_bf16 v[68:71], v[16:19], v[132:135], v[68:71]
  v_mfma_f32_16x16x32_bf16 v[72:75], v[16:19], v[128:131], v[72:75]
  v_mfma_f32_16x16x32_bf16 v[76:79], v[16:19], v[124:127], v[76:79]
  v_mfma_f32_16x16x32_bf16 v[80:83], v[16:19], v[120:123], v[80:83]
  v_mfma_f32_16x16x32_bf16 v[84:87], v[16:19], v[116:119], v[84:87]
  v_mfma_f32_16x16x32_bf16 v[88:91], v[16:19], v[112:115], v[88:91]
  v_mfma_f32_16x16x32_bf16 v[92:95], v[16:19], v[108:111], v[92:95]
  ds_read2_b32 v[16:17], v5 offset0:128 offset1:129
  ds_read2_b32 v[18:19], v5 offset0:130 offset1:131
  ds_write_b128 v7, v[68:71] offset:1280
  v_mfma_f32_16x16x32_bf16 v[72:75], v[20:23], v[132:135], v[72:75]
  v_mfma_f32_16x16x32_bf16 v[76:79], v[20:23], v[128:131], v[76:79]
  v_mfma_f32_16x16x32_bf16 v[80:83], v[20:23], v[124:127], v[80:83]
  v_mfma_f32_16x16x32_bf16 v[84:87], v[20:23], v[120:123], v[84:87]
  v_mfma_f32_16x16x32_bf16 v[88:91], v[20:23], v[116:119], v[88:91]
  v_mfma_f32_16x16x32_bf16 v[92:95], v[20:23], v[112:115], v[92:95]
  ds_read2_b32 v[20:21], v5 offset0:0 offset1:1
  ds_read2_b32 v[22:23], v5 offset0:2 offset1:3
  s_waitcnt lgkmcnt(10)
  v_mfma_f32_16x16x32_bf16 v[76:79], v[24:27], v[132:135], v[76:79]
  ds_write_b128 v7, v[72:75] offset:2560
  v_mfma_f32_16x16x32_bf16 v[80:83], v[24:27], v[128:131], v[80:83]
  s_lshr_b32 s42, s35, 1
  s_lshl_b32 s42, s42, 7
  s_add_u32 s42, s42, 32768
  s_add_u32 s8, s32, s42
  s_addc_u32 s9, s33, 0
  v_min_u32 v44, 6, v1
  v_lshlrev_b32 v44, 9, v44
  global_load_dword v45, v44, s[8:9] sc1
  s_lshl_b32 s42, s38, 7
  s_add_u32 s42, s42, 36864
  s_add_u32 s6, s32, s42
  s_addc_u32 s7, s33, 0
  v_mfma_f32_16x16x32_bf16 v[84:87], v[24:27], v[124:127], v[84:87]
  v_mfma_f32_16x16x32_bf16 v[88:91], v[24:27], v[120:123], v[88:91]
  v_mfma_f32_16x16x32_bf16 v[92:95], v[24:27], v[116:119], v[92:95]
  s_waitcnt lgkmcnt(9)
  v_mfma_f32_16x16x32_bf16 v[80:83], v[28:31], v[132:135], v[80:83]
  v_mfma_f32_16x16x32_bf16 v[84:87], v[28:31], v[128:131], v[84:87]
  ds_write_b128 v7, v[76:79] offset:3840
  v_mfma_f32_16x16x32_bf16 v[88:91], v[28:31], v[124:127], v[88:91]
  v_mfma_f32_16x16x32_bf16 v[92:95], v[28:31], v[120:123], v[92:95]
  s_waitcnt lgkmcnt(7)
  v_mfma_f32_16x16x32_bf16 v[84:87], v[32:35], v[132:135], v[84:87]
  v_mfma_f32_16x16x32_bf16 v[88:91], v[32:35], v[128:131], v[88:91]
  v_mfma_f32_16x16x32_bf16 v[92:95], v[32:35], v[124:127], v[92:95]
  ds_write_b128 v7, v[80:83] offset:5120
  s_waitcnt lgkmcnt(6)
  v_mfma_f32_16x16x32_bf16 v[88:91], v[16:19], v[132:135], v[88:91]
  v_mfma_f32_16x16x32_bf16 v[92:95], v[16:19], v[128:131], v[92:95]
  s_waitcnt lgkmcnt(3)
  v_mfma_f32_16x16x32_bf16 v[92:95], v[20:23], v[132:135], v[92:95]
  ds_write_b128 v7, v[84:87] offset:6400
  s_nop 3
  ds_write_b128 v7, v[88:91] offset:7680
  s_nop 1
  ds_write_b128 v7, v[92:95] offset:8960
  s_waitcnt lgkmcnt(0)
  s_barrier
  ds_read_b128 v[16:19], v37 offset:40960
  ds_read_b128 v[24:27], v37 offset:0
  ds_read_b128 v[48:51], v37 offset:10240
  ds_read_b128 v[20:23], v37 offset:51200
  ds_read_b128 v[28:31], v37 offset:20480
  ds_read_b128 v[52:55], v37 offset:30720
  s_waitcnt lgkmcnt(3)
  v_pk_add_f32 v[24:25], v[24:25], v[48:49]
  v_pk_add_f32 v[16:17], v[16:17], v[24:25]
  v_pk_add_f32 v[26:27], v[26:27], v[50:51]
  v_pk_add_f32 v[18:19], v[18:19], v[26:27]
  s_waitcnt lgkmcnt(0)
  v_pk_add_f32 v[28:29], v[28:29], v[52:53]
  v_pk_add_f32 v[20:21], v[20:21], v[28:29]
  v_pk_add_f32 v[30:31], v[30:31], v[54:55]
  v_pk_add_f32 v[22:23], v[22:23], v[30:31]
  v_cvt_pk_bf16_f32 v40, v16, v20
  v_cvt_pk_bf16_f32 v41, v17, v21
  v_cvt_pk_bf16_f32 v42, v18, v22
  v_cvt_pk_bf16_f32 v43, v19, v23
  global_store_dwordx4 v36, v[40:43], s[18:19] sc1
  s_lshl_b32 s42, s50, 6
  v_and_b32 v12, 31, v1
  v_lshl_add_u32 v12, v12, 1, s42
  global_load_ushort v13, v12, s[22:23]
  s_lshl_b32 s42, s39, 7
  v_and_b32 v12, 7, v1
  v_lshl_add_u32 v12, v12, 4, s42
  global_load_dwordx4 v[40:43], v12, s[26:27]
  s_mul_i32 s42, s39, 229376
  s_mul_i32 s44, s35, 28672
  s_add_u32 s44, s44, s42
  s_add_u32 s44, s44, 6291456
  s_and_b32 s54, s38, 0
  s_mul_i32 s43, s54, 12288
  s_add_u32 s46, s44, s43
  s_sub_u32 s48, s44, s43
  s_add_u32 s46, s46, 8192
  s_add_u32 s48, s48, 20480
  s_mul_i32 s54, s54, 3
  s_add_u32 s44, s32, s44
  s_addc_u32 s45, s33, 0
  s_add_u32 s46, s32, s46
  s_addc_u32 s47, s33, 0
  s_add_u32 s14, s46, 4096
  s_addc_u32 s15, s47, 0
  s_add_u32 s48, s32, s48
  s_addc_u32 s49, s33, 0
  s_add_u32 s52, s48, 4096
  s_addc_u32 s53, s49, 0
  v_lshlrev_b32 v23, 4, v1
  s_waitcnt vmcnt(3)
  v_cmp_ne_u32 vcc, s34, v45
  s_cbranch_vccz Lc4
  s_mov_b32 s55, 20000
Lf1A:
  global_load_dword v45, v44, s[8:9] sc1
  s_waitcnt vmcnt(0)
  v_cmp_ne_u32 vcc, s34, v45
  s_cbranch_vccz Lf1Ax
  s_sub_u32 s55, s55, 1
  s_cmp_lg_u32 s55, 0
  s_cbranch_scc1 Lf1A
Lf1Ax:
Lc4:
  global_load_dwordx4 v[96:99], v23, s[44:45] offset:0 sc1
  global_load_dwordx4 v[100:103], v23, s[44:45] offset:1024 sc1
  global_load_dwordx4 v[104:107], v23, s[44:45] offset:2048 sc1
  global_load_dwordx4 v[108:111], v23, s[44:45] offset:3072 sc1
  v_lshrrev_b32 v12, 4, v0
  v_and_b32 v15, 15, v0
  v_lshlrev_b32 v2, 13, v12
  v_lshl_add_u32 v2, v15, 4, v2
  v_mul_u32_u24 v14, 912, v15
  v_lshl_add_u32 v3, v12, 2, v14
  v_add_u32 v3, 61440, v3
  v_add_u32 v21, 128, v3
  v_mov_b32 v20, 0x3f803f80
  v_and_b32 v12, 31, v1
  v_lshrrev_b32 v15, 5, v1
  v_mul_u32_u24 v4, 912, v12
  v_lshl_add_u32 v4, v15, 4, v4
  v_add_u32 v4, 61440, v4
  v_mul_u32_u24 v22, 80, v12
  v_lshl_add_u32 v22, v15, 5, v22
  s_lshl_b32 s42, s35, 2
  s_add_u32 s42, s42, 120832
  v_add_u32 v22, s42, v22
  v_mul_u32_u24 v5, 80, v1
  v_add_u32 v5, 120832, v5
  s_lshl_b32 s42, s38, 8
  s_add_u32 s42, s42, 8388608
  s_add_u32 s56, s32, s42
  s_addc_u32 s57, s33, 0
  s_add_u32 s58, s56, 262144
  s_addc_u32 s59, s57, 0
  s_add_u32 s60, s58, 262144
  s_addc_u32 s61, s59, 0
  s_add_u32 s62, s60, 262144
  s_addc_u32 s63, s61, 0
  s_add_u32 s64, s62, 262144
  s_addc_u32 s65, s63, 0
  s_add_u32 s66, s64, 262144
  s_addc_u32 s67, s65, 0
  s_add_u32 s68, s66, 262144
  s_addc_u32 s69, s67, 0
  v_lshrrev_b32 v60, 5, v1
  v_bfe_u32 v61, v1, 2, 2
  v_lshl_add_u32 v60, v60, 3, v61
  v_bfe_u32 v61, v1, 4, 1
  v_lshlrev_b32 v60, 6, v60
  v_lshl_add_u32 v60, v61, 5, v60
  v_and_b32 v61, 3, v1
  v_lshl_add_u32 v60, v61, 3, v60
  s_lshl_b32 s42, s35, 10
  s_add_u32 s42, s42, 146688
  v_add_u32 v60, s42, v60
  v_lshlrev_b32 v61, 4, v0
  v_add_u32 v61, 146688, v61
  ds_write_b128 v61, v[168:171]
  ds_read_b64_tr_b16 v[168:169], v60 offset:0
  ds_read_b64_tr_b16 v[170:171], v60 offset:256
  ds_write_b128 v61, v[172:175]
  ds_read_b64_tr_b16 v[172:173], v60 offset:0
  ds_read_b64_tr_b16 v[174:175], v60 offset:256
  ds_write_b128 v61, v[176:179]
  ds_read_b64_tr_b16 v[176:177], v60 offset:0
  ds_read_b64_tr_b16 v[178:179], v60 offset:256
  ds_write_b128 v61, v[180:183]
  ds_read_b64_tr_b16 v[180:181], v60 offset:0
  ds_read_b64_tr_b16 v[182:183], v60 offset:256
  ds_write_b128 v61, v[184:187]
  ds_read_b64_tr_b16 v[184:185], v60 offset:0
  ds_read_b64_tr_b16 v[186:187], v60 offset:256
  ds_write_b128 v61, v[188:191]
  ds_read_b64_tr_b16 v[188:189], v60 offset:0
  ds_read_b64_tr_b16 v[190:191], v60 offset:256
  ds_write_b128 v61, v[192:195]
  ds_read_b64_tr_b16 v[192:193], v60 offset:0
  ds_read_b64_tr_b16 v[194:195], v60 offset:256
  ds_write_b128 v61, v[196:199]
  ds_read_b64_tr_b16 v[196:197], v60 offset:0
  ds_read_b64_tr_b16 v[198:199], v60 offset:256
  ds_write_b128 v61, v[200:203]
  ds_read_b64_tr_b16 v[200:201], v60 offset:0
  ds_read_b64_tr_b16 v[202:203], v60 offset:256
  ds_write_b128 v61, v[204:207]
  ds_read_b64_tr_b16 v[204:205], v60 offset:0
  ds_read_b64_tr_b16 v[206:207], v60 offset:256
  ds_write_b128 v61, v[208:211]
  ds_read_b64_tr_b16 v[208:209], v60 offset:0
  ds_read_b64_tr_b16 v[210:211], v60 offset:256
  ds_write_b128 v61, v[212:215]
  ds_read_b64_tr_b16 v[212:213], v60 offset:0
  ds_read_b64_tr_b16 v[214:215], v60 offset:256
  ds_write_b128 v61, v[216:219]
  ds_read_b64_tr_b16 v[216:217], v60 offset:0
  ds_read_b64_tr_b16 v[218:219], v60 offset:256
  ds_write_b128 v61, v[220:223]
  ds_read_b64_tr_b16 v[220:221], v60 offset:0
  ds_read_b64_tr_b16 v[222:223], v60 offset:256
  ds_write_b128 v61, v[224:227]
  ds_read_b64_tr_b16 v[224:225], v60 offset:0
  ds_read_b64_tr_b16 v[226:227], v60 offset:256
  ds_write_b128 v61, v[228:231]
  ds_read_b64_tr_b16 v[228:229], v60 offset:0
  ds_read_b64_tr_b16 v[230:231], v60 offset:256
  ds_write_b128 v61, v[232:235]
  ds_read_b64_tr_b16 v[232:233], v60 offset:0
  ds_read_b64_tr_b16 v[234:235], v60 offset:256
  ds_write_b128 v61, v[236:239]
  ds_read_b64_tr_b16 v[236:237], v60 offset:0
  ds_read_b64_tr_b16 v[238:239], v60 offset:256
  ds_write_b128 v61, v[240:243]
  ds_read_b64_tr_b16 v[240:241], v60 offset:0
  ds_read_b64_tr_b16 v[242:243], v60 offset:256
  ds_write_b128 v61, v[244:247]
  ds_read_b64_tr_b16 v[244:245], v60 offset:0
  ds_read_b64_tr_b16 v[246:247], v60 offset:256
  ds_write_b128 v61, v[248:251]
  ds_read_b64_tr_b16 v[248:249], v60 offset:0
  ds_read_b64_tr_b16 v[250:251], v60 offset:256
  ds_write_b128 v61, v[252:255]
  ds_read_b64_tr_b16 v[252:253], v60 offset:0
  ds_read_b64_tr_b16 v[254:255], v60 offset:256
  s_waitcnt vmcnt(6)
  global_load_dwordx4 v[64:67], v2, s[56:57] sc1
  global_load_dwordx4 v[68:71], v2, s[58:59] sc1
  global_load_dwordx4 v[72:75], v2, s[60:61] sc1
  global_load_dwordx4 v[76:79], v2, s[62:63] sc1
  global_load_dwordx4 v[80:83], v2, s[64:65] sc1
  global_load_dwordx4 v[84:87], v2, s[66:67] sc1
  global_load_dwordx4 v[88:91], v2, s[68:69] sc1
  v_mov_b32 v14, 0x3f803f80
  v_mov_b32 v16, 0
  v_mov_b32 v17, 0
  v_dot2c_f32_bf16 v16, v144, v14
  v_dot2c_f32_bf16 v17, v145, v14
  v_dot2c_f32_bf16 v16, v146, v14
  v_dot2c_f32_bf16 v17, v147, v14
  v_dot2c_f32_bf16 v16, v148, v14
  v_dot2c_f32_bf16 v17, v149, v14
  v_dot2c_f32_bf16 v16, v150, v14
  v_dot2c_f32_bf16 v17, v151, v14
  v_dot2c_f32_bf16 v16, v152, v14
  v_dot2c_f32_bf16 v17, v153, v14
  v_dot2c_f32_bf16 v16, v154, v14
  v_dot2c_f32_bf16 v17, v155, v14
  v_dot2c_f32_bf16 v16, v156, v14
  v_dot2c_f32_bf16 v17, v157, v14
  v_dot2c_f32_bf16 v16, v158, v14
  v_dot2c_f32_bf16 v17, v159, v14
  v_dot2c_f32_bf16 v16, v160, v14
  v_dot2c_f32_bf16 v17, v161, v14
  v_dot2c_f32_bf16 v16, v162, v14
  v_dot2c_f32_bf16 v17, v163, v14
  v_dot2c_f32_bf16 v16, v164, v14
  v_dot2c_f32_bf16 v17, v165, v14
  v_dot2c_f32_bf16 v16, v166, v14
  v_dot2c_f32_bf16 v17, v167, v14
  s_waitcnt lgkmcnt(15)
  v_dot2c_f32_bf16 v16, v168, v14
  v_dot2c_f32_bf16 v17, v169, v14
  s_waitcnt lgkmcnt(15)
  v_dot2c_f32_bf16 v16, v170, v14
  v_dot2c_f32_bf16 v17, v171, v14
  s_waitcnt lgkmcnt(15)
  v_dot2c_f32_bf16 v16, v172, v14
  v_dot2c_f32_bf16 v17, v173, v14
  s_waitcnt lgkmcnt(15)
  v_dot2c_f32_bf16 v16, v174, v14
  v_dot2c_f32_bf16 v17, v175, v14
  s_waitcnt lgkmcnt(15)
  v_dot2c_f32_bf16 v16, v176, v14
  v_dot2c_f32_bf16 v17, v177, v14
  s_waitcnt lgkmcnt(15)
  v_dot2c_f32_bf16 v16, v178, v14
  v_dot2c_f32_bf16 v17, v179, v14
  s_waitcnt lgkmcnt(15)
  v_dot2c_f32_bf16 v16, v180, v14
  v_dot2c_f32_bf16 v17, v181, v14
  s_waitcnt lgkmcnt(15)
  v_dot2c_f32_bf16 v16, v182, v14
  v_dot2c_f32_bf16 v17, v183, v14
  s_waitcnt lgkmcnt(15)
  v_dot2c_f32_bf16 v16, v184, v14
  v_dot2c_f32_bf16 v17, v185, v14
  s_waitcnt lgkmcnt(15)
  v_dot2c_f32_bf16 v16, v186, v14
  v_dot2c_f32_bf16 v17, v187, v14
  s_waitcnt lgkmcnt(15)
  v_dot2c_f32_bf16 v16, v188, v14
  v_dot2c_f32_bf16 v17, v189, v14
  s_waitcnt lgkmcnt(15)
  v_dot2c_f32_bf16 v16, v190, v14
  v_dot2c_f32_bf16 v17, v191, v14
  s_waitcnt lgkmcnt(15)
  v_dot2c_f32_bf16 v16, v192, v14
  v_dot2c_f32_bf16 v17, v193, v14
  s_waitcnt lgkmcnt(15)
  v_dot2c_f32_bf16 v16, v194, v14
  v_dot2c_f32_bf16 v17, v195, v14
  s_waitcnt lgkmcnt(15)
  v_dot2c_f32_bf16 v16, v196, v14
  v_dot2c_f32_bf16 v17, v197, v14
  s_waitcnt lgkmcnt(15)
  v_dot2c_f32_bf16 v16, v198, v14
  v_dot2c_f32_bf16 v17, v199, v14
  s_waitcnt lgkmcnt(15)
  v_dot2c_f32_bf16 v16, v200, v14
  v_dot2c_f32_bf16 v17, v201, v14
  s_waitcnt lgkmcnt(15)
  v_dot2c_f32_bf16 v16, v202, v14
  v_dot2c_f32_bf16 v17, v203, v14
  s_waitcnt lgkmcnt(15)
  v_dot2c_f32_bf16 v16, v204, v14
  v_dot2c_f32_bf16 v17, v205, v14
  s_waitcnt lgkmcnt(15)
  v_dot2c_f32_bf16 v16, v206, v14
  v_dot2c_f32_bf16 v17, v207, v14
  s_waitcnt lgkmcnt(15)
  v_dot2c_f32_bf16 v16, v208, v14
  v_dot2c_f32_bf16 v17, v209, v14
  s_waitcnt lgkmcnt(15)
  v_dot2c_f32_bf16 v16, v210, v14
  v_dot2c_f32_bf16 v17, v211, v14
  s_waitcnt lgkmcnt(15)
  v_dot2c_f32_bf16 v16, v212, v14
  v_dot2c_f32_bf16 v17, v213, v14
  s_waitcnt lgkmcnt(15)
  v_dot2c_f32_bf16 v16, v214, v14
  v_dot2c_f32_bf16 v17, v215, v14
  s_waitcnt lgkmcnt(15)
  v_dot2c_f32_bf16 v16, v216, v14
  v_dot2c_f32_bf16 v17, v217, v14
  s_waitcnt lgkmcnt(15)
  v_dot2c_f32_bf16 v16, v218, v14
  v_dot2c_f32_bf16 v17, v219, v14
  s_waitcnt lgkmcnt(15)
  v_dot2c_f32_bf16 v16, v220, v14
  v_dot2c_f32_bf16 v17, v221, v14
  s_waitcnt lgkmcnt(15)
  v_dot2c_f32_bf16 v16, v222, v14
  v_dot2c_f32_bf16 v17, v223, v14
  s_waitcnt lgkmcnt(15)
  v_dot2c_f32_bf16 v16, v224, v14
  v_dot2c_f32_bf16 v17, v225, v14
  s_waitcnt lgkmcnt(15)
  v_dot2c_f32_bf16 v16, v226, v14
  v_dot2c_f32_bf16 v17, v227, v14
  s_waitcnt lgkmcnt(15)
  v_dot2c_f32_bf16 v16, v228, v14
  v_dot2c_f32_bf16 v17, v229, v14
  s_waitcnt lgkmcnt(15)
  v_dot2c_f32_bf16 v16, v230, v14
  v_dot2c_f32_bf16 v17, v231, v14
  s_waitcnt lgkmcnt(15)
  v_dot2c_f32_bf16 v16, v232, v14
  v_dot2c_f32_bf16 v17, v233, v14
  s_waitcnt lgkmcnt(15)
  v_dot2c_f32_bf16 v16, v234, v14
  v_dot2c_f32_bf16 v17, v235, v14
  s_waitcnt lgkmcnt(13)
  v_dot2c_f32_bf16 v16, v236, v14
  v_dot2c_f32_bf16 v17, v237, v14
  s_waitcnt lgkmcnt(12)
  v_dot2c_f32_bf16 v16, v238, v14
  v_dot2c_f32_bf16 v17, v239, v14
  s_waitcnt lgkmcnt(10)
  v_dot2c_f32_bf16 v16, v240, v14
  v_dot2c_f32_bf16 v17, v241, v14
  s_waitcnt lgkmcnt(9)
  v_dot2c_f32_bf16 v16, v242, v14
  v_dot2c_f32_bf16 v17, v243, v14
  s_waitcnt lgkmcnt(7)
  v_dot2c_f32_bf16 v16, v244, v14
  v_dot2c_f32_bf16 v17, v245, v14
  s_waitcnt lgkmcnt(6)
  v_dot2c_f32_bf16 v16, v246, v14
  v_dot2c_f32_bf16 v17, v247, v14
  s_waitcnt lgkmcnt(4)
  v_dot2c_f32_bf16 v16, v248, v14
  v_dot2c_f32_bf16 v17, v249, v14
  s_waitcnt lgkmcnt(3)
  v_dot2c_f32_bf16 v16, v250, v14
  v_dot2c_f32_bf16 v17, v251, v14
  s_waitcnt lgkmcnt(1)
  v_dot2c_f32_bf16 v16, v252, v14
  v_dot2c_f32_bf16 v17, v253, v14
  s_waitcnt lgkmcnt(0)
  v_dot2c_f32_bf16 v16, v254, v14
  v_dot2c_f32_bf16 v17, v255, v14
  s_nop 2
  v_add_f32 v16, v16, v17
  v_mov_b32 v17, v16
  s_nop 1
  v_permlane32_swap_b32 v16, v17
  v_add_f32 v16, v16, v17
  v_cvt_pk_bf16_f32 v9, v16, v16
  v_and_b32 v17, 0xffff0000, v9
  v_sub_f32 v16, v16, v17
  v_cvt_pk_bf16_f32 v10, v16, 0
  s_waitcnt vmcnt(12)
  v_lshl_or_b32 v8, v13, 16, v13
  v_mov_b32 v11, 0
  v_mov_b32 v35, 0
  v_cmp_le_u32 vcc, 32, v1
  s_nop 1
  v_cndmask_b32 v32, 0, v8, vcc
  v_cndmask_b32 v33, 0, v9, vcc
  v_cndmask_b32 v34, 0, v10, vcc
  v_sub_u32 v8, v8, v32
  v_sub_u32 v9, v9, v33
  v_sub_u32 v10, v10, v34
  s_mul_i32 s42, s38, 229376
  s_lshl_b32 s43, s35, 12
  s_add_u32 s10, s42, s43
  s_add_u32 s10, s10, 10485760
  s_and_b32 s13, s38, 3
  s_mul_i32 s13, s13, 229376
  s_add_u32 s13, s13, s43
  s_add_u32 s13, s13, 4194304
  s_lshl_b32 s42, s39, 15
  s_add_u32 s42, s42, s10
  s_add_u32 s4, s32, s42
  s_addc_u32 s5, s33, 0
  v_lshrrev_b32 v12, 5, v1
  v_and_b32 v14, 31, v1
  v_mul_u32_u24 v6, 576, v12
  v_lshl_add_u32 v6, v14, 4, v6
  s_mul_i32 s11, s35, 4608
  s_add_u32 s12, s11, 36864
  v_add_u32 v6, s11, v6
  v_bfe_u32 v12, v0, 3, 5
  v_and_b32 v14, 7, v0
  v_mul_u32_u24 v39, 576, v14
  v_and_b32 v15, 31, v12
  v_lshl_add_u32 v39, v15, 4, v39
  s_lshl_b32 s42, s39, 7
  s_add_u32 s42, s42, 61440
  v_mul_u32_u24 v7, 912, v12
  v_lshl_add_u32 v7, v14, 4, v7
  v_add_u32 v7, s42, v7
  v_mov_b32 v24, 0
  v_mov_b32 v25, 0
  v_mov_b32 v26, 0
  v_mov_b32 v27, 0
  v_mov_b32 v28, 0
  v_mov_b32 v29, 0
  v_mov_b32 v30, 0
  v_mov_b32 v31, 0
  s_waitcnt vmcnt(6)
  ds_write2st64_b32 v3, v64, v65 offset0:0 offset1:57
  ds_write2st64_b32 v3, v66, v67 offset0:114 offset1:171
  v_dot2c_f32_bf16 v24, v64, v20
  v_dot2c_f32_bf16 v28, v64, v64
  v_dot2c_f32_bf16 v25, v65, v20
  v_dot2c_f32_bf16 v29, v65, v65
  v_dot2c_f32_bf16 v26, v66, v20
  v_dot2c_f32_bf16 v30, v66, v66
  v_dot2c_f32_bf16 v27, v67, v20
  v_dot2c_f32_bf16 v31, v67, v67
  v_max_u32 v12, v64, v65
  v_max3_u32 v12, v12, v66, v67
  s_waitcnt vmcnt(5)
  ds_write2st64_b32 v21, v68, v69 offset0:0 offset1:57
  ds_write2st64_b32 v21, v70, v71 offset0:114 offset1:171
  v_dot2c_f32_bf16 v24, v68, v20
  v_dot2c_f32_bf16 v28, v68, v68
  v_dot2c_f32_bf16 v25, v69, v20
  v_dot2c_f32_bf16 v29, v69, v69
  v_dot2c_f32_bf16 v26, v70, v20
  v_dot2c_f32_bf16 v30, v70, v70
  v_dot2c_f32_bf16 v27, v71, v20
  v_dot2c_f32_bf16 v31, v71, v71
  v_max3_u32 v12, v12, v68, v69
  v_max3_u32 v12, v12, v70, v71
  s_waitcnt vmcnt(4)
  ds_write2st64_b32 v3, v72, v73 offset0:1 offset1:58
  ds_write2st64_b32 v3, v74, v75 offset0:115 offset1:172
  v_dot2c_f32_bf16 v24, v72, v20
  v_dot2c_f32_bf16 v28, v72, v72
  v_dot2c_f32_bf16 v25, v73, v20
  v_dot2c_f32_bf16 v29, v73, v73
  v_dot2c_f32_bf16 v26, v74, v20
  v_dot2c_f32_bf16 v30, v74, v74
  v_dot2c_f32_bf16 v27, v75, v20
  v_dot2c_f32_bf16 v31, v75, v75
  v_max3_u32 v12, v12, v72, v73
  v_max3_u32 v12, v12, v74, v75
  s_waitcnt vmcnt(3)
  ds_write2st64_b32 v21, v76, v77 offset0:1 offset1:58
  ds_write2st64_b32 v21, v78, v79 offset0:115 offset1:172
  v_dot2c_f32_bf16 v24, v76, v20
  v_dot2c_f32_bf16 v28, v76, v76
  v_dot2c_f32_bf16 v25, v77, v20
  v_dot2c_f32_bf16 v29, v77, v77
  v_dot2c_f32_bf16 v26, v78, v20
  v_dot2c_f32_bf16 v30, v78, v78
  v_dot2c_f32_bf16 v27, v79, v20
  v_dot2c_f32_bf16 v31, v79, v79
  v_max3_u32 v12, v12, v76, v77
  v_max3_u32 v12, v12, v78, v79
  s_waitcnt vmcnt(2)
  ds_write2st64_b32 v3, v80, v81 offset0:2 offset1:59
  ds_write2st64_b32 v3, v82, v83 offset0:116 offset1:173
  v_dot2c_f32_bf16 v24, v80, v20
  v_dot2c_f32_bf16 v28, v80, v80
  v_dot2c_f32_bf16 v25, v81, v20
  v_dot2c_f32_bf16 v29, v81, v81
  v_dot2c_f32_bf16 v26, v82, v20
  v_dot2c_f32_bf16 v30, v82, v82
  v_dot2c_f32_bf16 v27, v83, v20
  v_dot2c_f32_bf16 v31, v83, v83
  v_max3_u32 v12, v12, v80, v81
  v_max3_u32 v12, v12, v82, v83
  s_waitcnt vmcnt(1)
  ds_write2st64_b32 v21, v84, v85 offset0:2 offset1:59
  ds_write2st64_b32 v21, v86, v87 offset0:116 offset1:173
  v_dot2c_f32_bf16 v24, v84, v20
  v_dot2c_f32_bf16 v28, v84, v84
  v_dot2c_f32_bf16 v25, v85, v20
  v_dot2c_f32_bf16 v29, v85, v85
  v_dot2c_f32_bf16 v26, v86, v20
  v_dot2c_f32_bf16 v30, v86, v86
  v_dot2c_f32_bf16 v27, v87, v20
  v_dot2c_f32_bf16 v31, v87, v87
  v_max3_u32 v12, v12, v84, v85
  v_max3_u32 v12, v12, v86, v87
  s_waitcnt vmcnt(0)
  ds_write2st64_b32 v3, v88, v89 offset0:3 offset1:60
  ds_write2st64_b32 v3, v90, v91 offset0:117 offset1:174
  v_dot2c_f32_bf16 v24, v88, v20
  v_dot2c_f32_bf16 v28, v88, v88
  v_dot2c_f32_bf16 v25, v89, v20
  v_dot2c_f32_bf16 v29, v89, v89
  v_dot2c_f32_bf16 v26, v90, v20
  v_dot2c_f32_bf16 v30, v90, v90
  v_dot2c_f32_bf16 v27, v91, v20
  v_dot2c_f32_bf16 v31, v91, v91
  v_max3_u32 v12, v12, v88, v89
  v_max3_u32 v12, v12, v90, v91
  v_cmp_eq_u32 vcc, -1, v12
  s_cbranch_vccz Lc5
  s_mov_b32 s55, 20000
LhgA:
  global_load_dwordx4 v[64:67], v2, s[56:57] sc1
  global_load_dwordx4 v[68:71], v2, s[58:59] sc1
  global_load_dwordx4 v[72:75], v2, s[60:61] sc1
  global_load_dwordx4 v[76:79], v2, s[62:63] sc1
  global_load_dwordx4 v[80:83], v2, s[64:65] sc1
  global_load_dwordx4 v[84:87], v2, s[66:67] sc1
  global_load_dwordx4 v[88:91], v2, s[68:69] sc1
  v_mov_b32 v24, 0
  v_mov_b32 v25, 0
  v_mov_b32 v26, 0
  v_mov_b32 v27, 0
  v_mov_b32 v28, 0
  v_mov_b32 v29, 0
  v_mov_b32 v30, 0
  v_mov_b32 v31, 0
  s_waitcnt vmcnt(6)
  ds_write2st64_b32 v3, v64, v65 offset0:0 offset1:57
  ds_write2st64_b32 v3, v66, v67 offset0:114 offset1:171
  v_dot2c_f32_bf16 v24, v64, v20
  v_dot2c_f32_bf16 v28, v64, v64
  v_dot2c_f32_bf16 v25, v65, v20
  v_dot2c_f32_bf16 v29, v65, v65
  v_dot2c_f32_bf16 v26, v66, v20
  v_dot2c_f32_bf16 v30, v66, v66
  v_dot2c_f32_bf16 v27, v67, v20
  v_dot2c_f32_bf16 v31, v67, v67
  v_max_u32 v12, v64, v65
  v_max3_u32 v12, v12, v66, v67
  s_waitcnt vmcnt(5)
  ds_write2st64_b32 v21, v68, v69 offset0:0 offset1:57
  ds_write2st64_b32 v21, v70, v71 offset0:114 offset1:171
  v_dot2c_f32_bf16 v24, v68, v20
  v_dot2c_f32_bf16 v28, v68, v68
  v_dot2c_f32_bf16 v25, v69, v20
  v_dot2c_f32_bf16 v29, v69, v69
  v_dot2c_f32_bf16 v26, v70, v20
  v_dot2c_f32_bf16 v30, v70, v70
  v_dot2c_f32_bf16 v27, v71, v20
  v_dot2c_f32_bf16 v31, v71, v71
  v_max3_u32 v12, v12, v68, v69
  v_max3_u32 v12, v12, v70, v71
  s_waitcnt vmcnt(4)
  ds_write2st64_b32 v3, v72, v73 offset0:1 offset1:58
  ds_write2st64_b32 v3, v74, v75 offset0:115 offset1:172
  v_dot2c_f32_bf16 v24, v72, v20
  v_dot2c_f32_bf16 v28, v72, v72
  v_dot2c_f32_bf16 v25, v73, v20
  v_dot2c_f32_bf16 v29, v73, v73
  v_dot2c_f32_bf16 v26, v74, v20
  v_dot2c_f32_bf16 v30, v74, v74
  v_dot2c_f32_bf16 v27, v75, v20
  v_dot2c_f32_bf16 v31, v75, v75
  v_max3_u32 v12, v12, v72, v73
  v_max3_u32 v12, v12, v74, v75
  s_waitcnt vmcnt(3)
  ds_write2st64_b32 v21, v76, v77 offset0:1 offset1:58
  ds_write2st64_b32 v21, v78, v79 offset0:115 offset1:172
  v_dot2c_f32_bf16 v24, v76, v20
  v_dot2c_f32_bf16 v28, v76, v76
  v_dot2c_f32_bf16 v25, v77, v20
  v_dot2c_f32_bf16 v29, v77, v77
  v_dot2c_f32_bf16 v26, v78, v20
  v_dot2c_f32_bf16 v30, v78, v78
  v_dot2c_f32_bf16 v27, v79, v20
  v_dot2c_f32_bf16 v31, v79, v79
  v_max3_u32 v12, v12, v76, v77
  v_max3_u32 v12, v12, v78, v79
  s_waitcnt vmcnt(2)
  ds_write2st64_b32 v3, v80, v81 offset0:2 offset1:59
  ds_write2st64_b32 v3, v82, v83 offset0:116 offset1:173
  v_dot2c_f32_bf16 v24, v80, v20
  v_dot2c_f32_bf16 v28, v80, v80
  v_dot2c_f32_bf16 v25, v81, v20
  v_dot2c_f32_bf16 v29, v81, v81
  v_dot2c_f32_bf16 v26, v82, v20
  v_dot2c_f32_bf16 v30, v82, v82
  v_dot2c_f32_bf16 v27, v83, v20
  v_dot2c_f32_bf16 v31, v83, v83
  v_max3_u32 v12, v12, v80, v81
  v_max3_u32 v12, v12, v82, v83
  s_waitcnt vmcnt(1)
  ds_write2st64_b32 v21, v84, v85 offset0:2 offset1:59
  ds_write2st64_b32 v21, v86, v87 offset0:116 offset1:173
  v_dot2c_f32_bf16 v24, v84, v20
  v_dot2c_f32_bf16 v28, v84, v84
  v_dot2c_f32_bf16 v25, v85, v20
  v_dot2c_f32_bf16 v29, v85, v85
  v_dot2c_f32_bf16 v26, v86, v20
  v_dot2c_f32_bf16 v30, v86, v86
  v_dot2c_f32_bf16 v27, v87, v20
  v_dot2c_f32_bf16 v31, v87, v87
  v_max3_u32 v12, v12, v84, v85
  v_max3_u32 v12, v12, v86, v87
  s_waitcnt vmcnt(0)
  ds_write2st64_b32 v3, v88, v89 offset0:3 offset1:60
  ds_write2st64_b32 v3, v90, v91 offset0:117 offset1:174
  v_dot2c_f32_bf16 v24, v88, v20
  v_dot2c_f32_bf16 v28, v88, v88
  v_dot2c_f32_bf16 v25, v89, v20
  v_dot2c_f32_bf16 v29, v89, v89
  v_dot2c_f32_bf16 v26, v90, v20
  v_dot2c_f32_bf16 v30, v90, v90
  v_dot2c_f32_bf16 v27, v91, v20
  v_dot2c_f32_bf16 v31, v91, v91
  v_max3_u32 v12, v12, v88, v89
  v_max3_u32 v12, v12, v90, v91
  v_cmp_eq_u32 vcc, -1, v12
  s_cbranch_vccz LhgAx
  s_sub_u32 s55, s55, 1
  s_cmp_lg_u32 s55, 0
  s_cbranch_scc1 LhgA
LhgAx:
Lc5:
  s_nop 2
  v_permlane32_swap_b32 v24, v28
  v_permlane32_swap_b32 v25, v29
  v_permlane32_swap_b32 v26, v30
  v_permlane32_swap_b32 v27, v31
  v_add_f32 v24, v24, v28
  v_add_f32 v25, v25, v29
  v_add_f32 v26, v26, v30
  v_add_f32 v27, v27, v31
  v_permlane16_swap_b32 v24, v25
  s_nop 0
  v_permlane16_swap_b32 v26, v27
  v_add_f32 v24, v24, v25
  v_add_f32 v26, v26, v27
  ds_write2st64_b32 v22, v24, v26 offset0:0 offset1:10
  s_or_b32 s42, s36, s35
  s_cmp_eq_u32 s42, 0
  s_cbranch_scc0 Lc6
  s_xor_b32 s42, s34, 0x5bd1e995
  s_add_u32 s42, s42, 1
  v_mov_b32 v12, 0
  v_mov_b32 v13, s42
  s_mov_b64 exec, 1
  global_store_dword v12, v13, s[32:33] sc1
  s_mov_b64 exec, -1
Lc6:
  s_mul_i32 s42, s51, 448
  v_subrev_u32 v3, s42, v4
  v_add_u32 v4, s42, v4
  v_lshlrev_b32 v2, 4, v1
  global_load_dword v47, v11, s[6:7] sc1
  global_load_dwordx4 v[112:115], v2, s[46:47] offset:-4096 sc1
  global_load_dwordx4 v[116:119], v2, s[46:47] offset:-3072 sc1
  global_load_dwordx4 v[120:123], v2, s[46:47] offset:-2048 sc1
  global_load_dwordx4 v[124:127], v2, s[46:47] offset:-1024 sc1
  global_load_dwordx4 v[128:131], v2, s[46:47] offset:0 sc1
  global_load_dwordx4 v[132:135], v2, s[46:47] offset:1024 sc1
  s_waitcnt lgkmcnt(0)
  s_barrier
  s_setprio 1
  ds_read_b128 v[48:51], v4 offset:0
  ds_read_b128 v[52:55], v4 offset:32
  ds_read_b128 v[56:59], v4 offset:64
  ds_read_b128 v[16:19], v5 offset:0
  ds_read_b128 v[20:23], v5 offset:16
  ds_read_b128 v[24:27], v5 offset:32
  ds_read_b128 v[28:31], v5 offset:48
  ds_read_b128 v[60:63], v4 offset:96
  s_waitcnt lgkmcnt(7)
  v_mfma_f32_32x32x16_bf16 v[64:79], v[144:147], v[48:51], 0
  global_load_dwordx4 v[136:139], v2, s[46:47] offset:2048 sc1
  ds_read_b128 v[48:51], v4 offset:128
  s_waitcnt lgkmcnt(7)
  v_mfma_f32_32x32x16_bf16 v[64:79], v[148:151], v[52:55], v[64:79]
  ds_read_b128 v[52:55], v4 offset:160
  s_waitcnt lgkmcnt(7)
  v_mfma_f32_32x32x16_bf16 v[64:79], v[152:155], v[56:59], v[64:79]
  global_load_dwordx4 v[140:143], v2, s[46:47] offset:3072 sc1
  s_waitcnt lgkmcnt(5)
  v_add_f32 v16, v16, v20
  s_waitcnt lgkmcnt(3)
  v_add_f32 v24, v24, v28
  v_add_f32 v17, v17, v21
  ds_read_b128 v[56:59], v4 offset:192
  s_waitcnt lgkmcnt(3)
  v_mfma_f32_32x32x16_bf16 v[64:79], v[156:159], v[60:63], v[64:79]
  v_add_f32 v25, v25, v29
  v_add_f32 v18, v18, v22
  ds_read_b128 v[60:63], v4 offset:224
  s_waitcnt lgkmcnt(3)
  v_mfma_f32_32x32x16_bf16 v[64:79], v[160:163], v[48:51], v[64:79]
  v_add_f32 v26, v26, v30
  v_add_f32 v19, v19, v23
  ds_read_b128 v[48:51], v4 offset:256
  s_waitcnt lgkmcnt(3)
  v_mfma_f32_32x32x16_bf16 v[64:79], v[164:167], v[52:55], v[64:79]
  s_mov_b32 m0, s11
  s_nop 0
  global_load_lds_dwordx4 v2, s[48:49] offset:0 sc1
  v_add_f32 v27, v27, v31
  v_add_f32 v16, v16, v18
  ds_read_b128 v[52:55], v4 offset:288
  s_waitcnt lgkmcnt(3)
  v_mfma_f32_32x32x16_bf16 v[64:79], v[168:171], v[56:59], v[64:79]
  v_add_f32 v24, v24, v26
  v_add_f32 v17, v17, v19
  v_add_f32 v25, v25, v27
  ds_read_b128 v[56:59], v4 offset:320
  s_waitcnt lgkmcnt(3)
  v_mfma_f32_32x32x16_bf16 v[64:79], v[172:175], v[60:63], v[64:79]
  v_add_f32 v16, v16, v17
  v_add_f32 v17, v24, v25
  ds_read_b128 v[60:63], v4 offset:352
  s_waitcnt lgkmcnt(3)
  v_mfma_f32_32x32x16_bf16 v[64:79], v[176:179], v[48:51], v[64:79]
  global_load_lds_dwordx4 v2, s[48:49] offset:1024 sc1
  v_mul_f32 v19, 0xbb124925, v16
  v_mul_f32 v17, 0x3b124925, v17
  ds_read_b128 v[48:51], v4 offset:384
  s_waitcnt lgkmcnt(3)
  v_mfma_f32_32x32x16_bf16 v[64:79], v[180:183], v[52:55], v[64:79]
  v_fma_f32 v17, -v19, v19, v17
  v_max_f32 v17, 0, v17
  ds_read_b128 v[52:55], v4 offset:416
  s_waitcnt lgkmcnt(3)
  v_mfma_f32_32x32x16_bf16 v[64:79], v[184:187], v[56:59], v[64:79]
  v_add_f32 v18, 0x3727c5ac, v17
  v_sqrt_f32 v18, v18
  ds_read_b128 v[56:59], v3 offset:448
  s_waitcnt lgkmcnt(3)
  v_mfma_f32_32x32x16_bf16 v[64:79], v[188:191], v[60:63], v[64:79]
  global_load_lds_dwordx4 v2, s[48:49] offset:2048 sc1
  v_cvt_pk_bf16_f32 v21, v19, v19
  v_and_b32 v21, 0xffff0000, v21
  v_cvt_pk_bf16_f32 v18, v18, v18
  ds_read_b128 v[60:63], v3 offset:480
  s_waitcnt lgkmcnt(3)
  v_mfma_f32_32x32x16_bf16 v[64:79], v[192:195], v[48:51], v[64:79]
  v_and_b32 v18, 0xffff0000, v18
  v_rcp_f32 v20, v18
  ds_read_b128 v[48:51], v3 offset:512
  s_waitcnt lgkmcnt(3)
  v_mfma_f32_32x32x16_bf16 v[64:79], v[196:199], v[52:55], v[64:79]
  v_sub_f32 v16, v19, v21
  v_mul_f32 v17, v17, v20
  ds_read_b128 v[52:55], v3 offset:544
  s_waitcnt lgkmcnt(3)
  v_mfma_f32_32x32x16_bf16 v[64:79], v[200:203], v[56:59], v[64:79]
  global_load_lds_dwordx4 v2, s[48:49] offset:3072 sc1
  v_cvt_pk_bf16_f32 v13, v21, v16
  v_mul_f32 v17, v17, v20
  ds_read_b128 v[56:59], v3 offset:576
  s_waitcnt lgkmcnt(3)
  v_mfma_f32_32x32x16_bf16 v[64:79], v[204:207], v[60:63], v[64:79]
  v_cvt_pk_bf16_f32 v17, v17, v17
  v_and_b32 v17, 0xffff0000, v17
  ds_read_b128 v[60:63], v3 offset:608
  s_waitcnt lgkmcnt(3)
  v_mfma_f32_32x32x16_bf16 v[64:79], v[208:211], v[48:51], v[64:79]
  s_mov_b32 m0, s12
  s_nop 0
  global_load_lds_dwordx4 v2, s[52:53] offset:0 sc1
  v_add_f32 v17, 0x3727c5ac, v17
  v_sqrt_f32 v17, v17
  v_lshrrev_b32 v14, 16, v21
  ds_read_b128 v[48:51], v3 offset:640
  s_waitcnt lgkmcnt(3)
  v_mfma_f32_32x32x16_bf16 v[64:79], v[212:215], v[52:55], v[64:79]
  v_cvt_pk_bf16_f32 v17, v17, v17
  v_and_b32 v17, 0xffff0000, v17
  ds_read_b128 v[52:55], v3 offset:672
  s_waitcnt lgkmcnt(3)
  v_mfma_f32_32x32x16_bf16 v[64:79], v[216:219], v[56:59], v[64:79]
  v_mul_f32 v36, v18, v17
  v_rcp_f32 v20, v36
  ds_read_b128 v[56:59], v3 offset:704
  s_waitcnt lgkmcnt(3)
  v_mfma_f32_32x32x16_bf16 v[64:79], v[220:223], v[60:63], v[64:79]
  global_load_lds_dwordx4 v2, s[52:53] offset:1024 sc1
  v_cvt_pk_bf16_f32 v18, v36, v36
  v_and_b32 v18, 0xffff0000, v18
  ds_read_b128 v[60:63], v3 offset:736
  s_waitcnt lgkmcnt(3)
  v_mfma_f32_32x32x16_bf16 v[64:79], v[224:227], v[48:51], v[64:79]
  v_sub_f32 v17, v36, v18
  v_mul_f32 v37, 0xc0135761, v20
  ds_read_b128 v[48:51], v3 offset:768
  s_waitcnt lgkmcnt(3)
  v_mfma_f32_32x32x16_bf16 v[64:79], v[228:231], v[52:55], v[64:79]
  v_cvt_pk_bf16_f32 v12, v18, v17
  v_mov_b32 v15, 0
  v_mul_f32 v20, v20, v20
  ds_read_b128 v[52:55], v3 offset:800
  s_waitcnt lgkmcnt(3)
  v_mfma_f32_32x32x16_bf16 v[64:79], v[232:235], v[56:59], v[64:79]
  global_load_lds_dwordx4 v2, s[52:53] offset:2048 sc1
  v_mul_f32 v20, 0x3d372713, v20
  v_mul_f32 v38, v20, v37
  ds_read_b128 v[56:59], v3 offset:832
  s_waitcnt lgkmcnt(3)
  v_mfma_f32_32x32x16_bf16 v[64:79], v[236:239], v[60:63], v[64:79]
  v_mov_b32 v44, v36
  v_mov_b32 v45, v37
  ds_read_b128 v[60:63], v3 offset:864
  s_waitcnt lgkmcnt(3)
  v_mfma_f32_32x32x16_bf16 v[64:79], v[240:243], v[48:51], v[64:79]
  v_mov_b32 v46, v38
  v_permlane32_swap_b32 v36, v44
  ds_read_b128 v[48:51], v4 offset:29184
  s_waitcnt lgkmcnt(3)
  v_mfma_f32_32x32x16_bf16 v[64:79], v[244:247], v[52:55], v[64:79]
  global_load_lds_dwordx4 v2, s[52:53] offset:3072 sc1
  v_permlane32_swap_b32 v37, v45
  v_permlane32_swap_b32 v38, v46
  ds_read_b128 v[52:55], v4 offset:29216
  s_waitcnt lgkmcnt(3)
  v_mfma_f32_32x32x16_bf16 v[64:79], v[248:251], v[56:59], v[64:79]
  ds_read_b128 v[56:59], v4 offset:29248
  s_waitcnt lgkmcnt(3)
  v_mfma_f32_32x32x16_bf16 v[64:79], v[252:255], v[60:63], v[64:79]
  v_mfma_f32_32x32x16_bf16 v[64:79], v[8:11], v[12:15], v[64:79]
  s_setprio 0
  s_waitcnt vmcnt(16)
  v_cmp_ne_u32 vcc, s34, v47
  s_cbranch_vccz Lc7
  s_mov_b32 s55, 20000
Lf2A:
  global_load_dword v47, v11, s[6:7] sc1
  s_waitcnt vmcnt(0)
  v_cmp_ne_u32 vcc, s34, v47
  s_cbranch_vccz Lf2Ax
  s_sub_u32 s55, s55, 1
  s_cmp_lg_u32 s55, 0
  s_cbranch_scc1 Lf2A
Lf2Ax:
Lc7:
  ds_read_b128 v[60:63], v4 offset:29280
  s_waitcnt lgkmcnt(3)
  v_mfma_f32_32x32x16_bf16 v[80:95], v[144:147], v[48:51], 0
  global_load_dwordx4 v[144:147], v2, s[14:15] offset:0 sc1
  s_nop 3
  v_mul_f32 v16, v64, v64
  v_mul_f32 v17, v65, v65
  v_mul_f32 v18, v66, v66
  v_mul_f32 v19, v67, v67
  v_fma_f32 v16, v16, v38, v37
  v_fma_f32 v17, v17, v38, v37
  v_fma_f32 v18, v18, v38, v37
  v_fma_f32 v19, v19, v38, v37
  v_mul_f32 v16, v16, v64
  v_mul_f32 v17, v17, v65
  v_mul_f32 v18, v18, v66
  v_mul_f32 v19, v19, v67
  v_exp_f32 v16, v16
  v_exp_f32 v17, v17
  v_exp_f32 v18, v18
  v_exp_f32 v19, v19
  v_fma_f32 v16, v16, v36, v36
  v_fma_f32 v17, v17, v36, v36
  v_fma_f32 v18, v18, v36, v36
  v_fma_f32 v19, v19, v36, v36
  v_rcp_f32 v16, v16
  v_rcp_f32 v17, v17
  v_rcp_f32 v18, v18
  v_rcp_f32 v19, v19
  v_mul_f32 v16, v16, v64
  v_mul_f32 v17, v17, v65
  v_mul_f32 v18, v18, v66
  v_mul_f32 v19, v19, v67
  v_cvt_pk_bf16_f32 v24, v16, v17
  v_cvt_pk_bf16_f32 v25, v18, v19
  v_mul_f32 v20, v68, v68
  v_mul_f32 v21, v69, v69
  v_mul_f32 v22, v70, v70
  v_mul_f32 v23, v71, v71
  v_fma_f32 v20, v20, v38, v37
  v_fma_f32 v21, v21, v38, v37
  v_fma_f32 v22, v22, v38, v37
  v_fma_f32 v23, v23, v38, v37
  v_mul_f32 v20, v20, v68
  v_mul_f32 v21, v21, v69
  v_mul_f32 v22, v22, v70
  v_mul_f32 v23, v23, v71
  v_exp_f32 v20, v20
  v_exp_f32 v21, v21
  v_exp_f32 v22, v22
  v_exp_f32 v23, v23
  v_fma_f32 v20, v20, v36, v36
  v_fma_f32 v21, v21, v36, v36
  v_fma_f32 v22, v22, v36, v36
  v_fma_f32 v23, v23, v36, v36
  v_rcp_f32 v20, v20
  v_rcp_f32 v21, v21
  v_rcp_f32 v22, v22
  v_rcp_f32 v23, v23
  v_mul_f32 v20, v20, v68
  v_mul_f32 v21, v21, v69
  v_mul_f32 v22, v22, v70
  v_mul_f32 v23, v23, v71
  v_cvt_pk_bf16_f32 v26, v20, v21
  v_cvt_pk_bf16_f32 v27, v22, v23
  global_store_dwordx4 v2, v[24:27], s[4:5] offset:0 sc1
  v_mul_f32 v16, v72, v72
  v_mul_f32 v17, v73, v73
  v_mul_f32 v18, v74, v74
  v_mul_f32 v19, v75, v75
  v_fma_f32 v16, v16, v38, v37
  v_fma_f32 v17, v17, v38, v37
  v_fma_f32 v18, v18, v38, v37
  v_fma_f32 v19, v19, v38, v37
  v_mul_f32 v16, v16, v72
  v_mul_f32 v17, v17, v73
  v_mul_f32 v18, v18, v74
  v_mul_f32 v19, v19, v75
  v_exp_f32 v16, v16
  v_exp_f32 v17, v17
  v_exp_f32 v18, v18
  v_exp_f32 v19, v19
  v_fma_f32 v16, v16, v36, v36
  v_fma_f32 v17, v17, v36, v36
  v_fma_f32 v18, v18, v36, v36
  v_fma_f32 v19, v19, v36, v36
  v_rcp_f32 v16, v16
  v_rcp_f32 v17, v17
  v_rcp_f32 v18, v18
  v_rcp_f32 v19, v19
  v_mul_f32 v16, v16, v72
  v_mul_f32 v17, v17, v73
  v_mul_f32 v18, v18, v74
  v_mul_f32 v19, v19, v75
  v_cvt_pk_bf16_f32 v28, v16, v17
  v_cvt_pk_bf16_f32 v29, v18, v19
  v_mul_f32 v20, v76, v76
  v_mul_f32 v21, v77, v77
  v_mul_f32 v22, v78, v78
  v_mul_f32 v23, v79, v79
  v_fma_f32 v20, v20, v38, v37
  v_fma_f32 v21, v21, v38, v37
  v_fma_f32 v22, v22, v38, v37
  v_fma_f32 v23, v23, v38, v37
  v_mul_f32 v20, v20, v76
  v_mul_f32 v21, v21, v77
  v_mul_f32 v22, v22, v78
  v_mul_f32 v23, v23, v79
  v_exp_f32 v20, v20
  v_exp_f32 v21, v21
  v_exp_f32 v22, v22
  v_exp_f32 v23, v23
  v_fma_f32 v20, v20, v36, v36
  v_fma_f32 v21, v21, v36, v36
  v_fma_f32 v22, v22, v36, v36
  v_fma_f32 v23, v23, v36, v36
  v_rcp_f32 v20, v20
  v_rcp_f32 v21, v21
  v_rcp_f32 v22, v22
  v_rcp_f32 v23, v23
  v_mul_f32 v20, v20, v76
  v_mul_f32 v21, v21, v77
  v_mul_f32 v22, v22, v78
  v_mul_f32 v23, v23, v79
  v_cvt_pk_bf16_f32 v30, v20, v21
  v_cvt_pk_bf16_f32 v31, v22, v23
  global_store_dwordx4 v2, v[28:31], s[4:5] offset:1024 sc1
  s_setprio 1
  ds_read_b128 v[48:51], v4 offset:29312
  s_waitcnt lgkmcnt(3)
  v_mfma_f32_32x32x16_bf16 v[80:95], v[148:151], v[52:55], v[80:95]
  global_load_dwordx4 v[148:151], v2, s[14:15] offset:1024 sc1
  ds_read_b128 v[52:55], v4 offset:29344
  s_waitcnt lgkmcnt(3)
  v_mfma_f32_32x32x16_bf16 v[80:95], v[152:155], v[56:59], v[80:95]
  v_add_u32 v8, s11, v2
  v_add_u32 v9, s12, v2
  ds_read_b128 v[56:59], v4 offset:29376
  s_waitcnt lgkmcnt(3)
  v_mfma_f32_32x32x16_bf16 v[80:95], v[156:159], v[60:63], v[80:95]
  global_load_dwordx4 v[152:155], v2, s[14:15] offset:2048 sc1
  ds_read_b128 v[60:63], v4 offset:29408
  s_waitcnt lgkmcnt(3)
  v_mfma_f32_32x32x16_bf16 v[80:95], v[160:163], v[48:51], v[80:95]
  global_load_dwordx4 v[156:159], v2, s[14:15] offset:3072 sc1
  ds_read_b128 v[48:51], v4 offset:29440
  s_waitcnt lgkmcnt(3)
  v_mfma_f32_32x32x16_bf16 v[80:95], v[164:167], v[52:55], v[80:95]
  ds_read_b128 v[52:55], v4 offset:29472
  s_waitcnt lgkmcnt(3)
  v_mfma_f32_32x32x16_bf16 v[80:95], v[168:171], v[56:59], v[80:95]
  global_load_dwordx4 v[160:163], v2, s[48:49] offset:-4096 sc1
  ds_read_b128 v[56:59], v4 offset:29504
  s_waitcnt lgkmcnt(3)
  v_mfma_f32_32x32x16_bf16 v[80:95], v[172:175], v[60:63], v[80:95]
  global_load_dwordx4 v[164:167], v2, s[48:49] offset:-3072 sc1
  ds_read_b128 v[60:63], v4 offset:29536
  s_waitcnt lgkmcnt(3)
  v_mfma_f32_32x32x16_bf16 v[80:95], v[176:179], v[48:51], v[80:95]
  ds_read_b128 v[48:51], v4 offset:29568
  s_waitcnt lgkmcnt(3)
  v_mfma_f32_32x32x16_bf16 v[80:95], v[180:183], v[52:55], v[80:95]
  global_load_dwordx4 v[168:171], v2, s[48:49] offset:-2048 sc1
  ds_read_b128 v[52:55], v4 offset:29600
  s_waitcnt lgkmcnt(3)
  v_mfma_f32_32x32x16_bf16 v[80:95], v[184:187], v[56:59], v[80:95]
  global_load_dwordx4 v[172:175], v2, s[48:49] offset:-1024 sc1
  ds_read_b128 v[56:59], v3 offset:29632
  s_waitcnt lgkmcnt(3)
  v_mfma_f32_32x32x16_bf16 v[80:95], v[188:191], v[60:63], v[80:95]
  ds_read_b128 v[60:63], v3 offset:29664
  s_waitcnt lgkmcnt(3)
  v_mfma_f32_32x32x16_bf16 v[80:95], v[192:195], v[48:51], v[80:95]
  s_add_u32 s42, s39, 1
  s_add_u32 s42, s42, s54
  s_cmp_ge_u32 s42, 7
  s_cselect_b32 s43, 7, 0
  s_sub_u32 s42, s42, s43
  ds_read_b128 v[48:51], v3 offset:29696
  s_waitcnt lgkmcnt(3)
  v_mfma_f32_32x32x16_bf16 v[80:95], v[196:199], v[52:55], v[80:95]
  s_lshl_b32 s42, s42, 15
  s_add_u32 s42, s42, s10
  s_add_u32 s56, s32, s42
  s_addc_u32 s57, s33, 0
  ds_read_b128 v[52:55], v3 offset:29728
  s_waitcnt lgkmcnt(3)
  v_mfma_f32_32x32x16_bf16 v[80:95], v[200:203], v[56:59], v[80:95]
  s_add_u32 s42, s39, 2
  s_add_u32 s42, s42, s54
  s_cmp_ge_u32 s42, 7
  s_cselect_b32 s43, 7, 0
  s_sub_u32 s42, s42, s43
  ds_read_b128 v[56:59], v3 offset:29760
  s_waitcnt lgkmcnt(3)
  v_mfma_f32_32x32x16_bf16 v[80:95], v[204:207], v[60:63], v[80:95]
  s_waitcnt vmcnt(10)
  s_lshl_b32 s42, s42, 15
  s_add_u32 s42, s42, s10
  s_add_u32 s58, s32, s42
  s_addc_u32 s59, s33, 0
  ds_read_b128 v[60:63], v3 offset:29792
  s_waitcnt lgkmcnt(3)
  v_mfma_f32_32x32x16_bf16 v[80:95], v[208:211], v[48:51], v[80:95]
  ds_read_b128 v[176:179], v8 offset:0
  s_add_u32 s42, s39, 3
  s_add_u32 s42, s42, s54
  s_cmp_ge_u32 s42, 7
  s_cselect_b32 s43, 7, 0
  s_sub_u32 s42, s42, s43
  ds_read_b128 v[48:51], v3 offset:29824
  s_waitcnt lgkmcnt(4)
  v_mfma_f32_32x32x16_bf16 v[80:95], v[212:215], v[52:55], v[80:95]
  ds_read_b128 v[180:183], v8 offset:1024
  ds_read_b128 v[52:55], v3 offset:29856
  s_waitcnt lgkmcnt(5)
  v_mfma_f32_32x32x16_bf16 v[80:95], v[216:219], v[56:59], v[80:95]
  ds_read_b128 v[184:187], v8 offset:2048
  s_lshl_b32 s42, s42, 15
  s_add_u32 s42, s42, s10
  s_add_u32 s60, s32, s42
  s_addc_u32 s61, s33, 0
  ds_read_b128 v[56:59], v3 offset:29888
  s_waitcnt lgkmcnt(6)
  v_mfma_f32_32x32x16_bf16 v[80:95], v[220:223], v[60:63], v[80:95]
  ds_read_b128 v[188:191], v8 offset:3072
  s_add_u32 s42, s39, 4
  s_sub_u32 s42, s42, s54
  s_cmp_ge_u32 s42, 7
  s_cselect_b32 s43, 7, 0
  s_sub_u32 s42, s42, s43
  ds_read_b128 v[60:63], v3 offset:29920
  s_waitcnt lgkmcnt(6)
  v_mfma_f32_32x32x16_bf16 v[80:95], v[224:227], v[48:51], v[80:95]
  ds_read_b128 v[192:195], v9 offset:0
  s_lshl_b32 s42, s42, 15
  s_add_u32 s42, s42, s10
  s_add_u32 s62, s32, s42
  s_addc_u32 s63, s33, 0
  ds_read_b128 v[48:51], v3 offset:29952
  s_waitcnt lgkmcnt(6)
  v_mfma_f32_32x32x16_bf16 v[80:95], v[228:231], v[52:55], v[80:95]
  ds_read_b128 v[196:199], v9 offset:1024
  s_add_u32 s42, s39, 5
  s_sub_u32 s42, s42, s54
  s_cmp_ge_u32 s42, 7
  s_cselect_b32 s43, 7, 0
  s_sub_u32 s42, s42, s43
  ds_read_b128 v[52:55], v3 offset:29984
  s_waitcnt lgkmcnt(6)
  v_mfma_f32_32x32x16_bf16 v[80:95], v[232:235], v[56:59], v[80:95]
  ds_read_b128 v[200:203], v9 offset:2048
  ds_read_b128 v[56:59], v3 offset:30016
  s_waitcnt lgkmcnt(6)
  v_mfma_f32_32x32x16_bf16 v[80:95], v[236:239], v[60:63], v[80:95]
  ds_read_b128 v[204:207], v9 offset:3072
  s_lshl_b32 s42, s42, 15
  s_add_u32 s42, s42, s10
  s_add_u32 s64, s32, s42
  s_addc_u32 s65, s33, 0
  ds_read_b128 v[60:63], v3 offset:30048
  s_waitcnt lgkmcnt(6)
  v_mfma_f32_32x32x16_bf16 v[80:95], v[240:243], v[48:51], v[80:95]
  s_add_u32 s42, s39, 6
  s_sub_u32 s42, s42, s54
  s_cmp_ge_u32 s42, 7
  s_cselect_b32 s43, 7, 0
  s_sub_u32 s42, s42, s43
  s_waitcnt lgkmcnt(4)
  v_mfma_f32_32x32x16_bf16 v[80:95], v[244:247], v[52:55], v[80:95]
  s_lshl_b32 s42, s42, 15
  s_add_u32 s42, s42, s10
  s_add_u32 s66, s32, s42
  s_addc_u32 s67, s33, 0
  s_waitcnt lgkmcnt(2)
  v_mfma_f32_32x32x16_bf16 v[80:95], v[248:251], v[56:59], v[80:95]
  s_mul_i32 s42, s38, 57344
  s_lshl_b32 s43, s39, 7
  s_add_u32 s42, s42, s43
  s_add_u32 s68, s28, s42
  s_addc_u32 s69, s29, 0
  s_waitcnt lgkmcnt(0)
  v_mfma_f32_32x32x16_bf16 v[80:95], v[252:255], v[60:63], v[80:95]
  v_mfma_f32_32x32x16_bf16 v[80:95], v[32:35], v[12:15], v[80:95]
  s_setprio 0
  v_bfe_u32 v8, v0, 3, 5
  v_and_b32 v9, 15, v8
  v_lshrrev_b32 v8, 4, v8
  v_lshl_add_u32 v8, v9, 2, v8
  v_and_b32 v9, 7, v0
  v_mul_u32_u24 v3, 896, v8
  v_lshl_add_u32 v3, v9, 4, v3
  s_nop 3
  v_mul_f32 v16, v80, v80
  v_mul_f32 v17, v81, v81
  v_mul_f32 v18, v82, v82
  v_mul_f32 v19, v83, v83
  v_fma_f32 v16, v16, v46, v45
  v_fma_f32 v17, v17, v46, v45
  v_fma_f32 v18, v18, v46, v45
  v_fma_f32 v19, v19, v46, v45
  v_mul_f32 v16, v16, v80
  v_mul_f32 v17, v17, v81
  global_load_dwordx4 v[208:211], v2, s[56:57] offset:0 sc1
  v_mul_f32 v18, v18, v82
  v_mul_f32 v19, v19, v83
  v_exp_f32 v16, v16
  v_exp_f32 v17, v17
  v_exp_f32 v18, v18
  v_exp_f32 v19, v19
  v_fma_f32 v16, v16, v44, v44
  v_fma_f32 v17, v17, v44, v44
  v_fma_f32 v18, v18, v44, v44
  global_load_dwordx4 v[212:215], v2, s[56:57] offset:1024 sc1
  v_fma_f32 v19, v19, v44, v44
  v_rcp_f32 v16, v16
  v_rcp_f32 v17, v17
  v_rcp_f32 v18, v18
  v_rcp_f32 v19, v19
  v_mul_f32 v16, v16, v80
  v_mul_f32 v17, v17, v81
  v_mul_f32 v18, v18, v82
  v_mul_f32 v19, v19, v83
  v_cvt_pk_bf16_f32 v48, v16, v17
  global_load_dwordx4 v[216:219], v2, s[58:59] offset:0 sc1
  v_cvt_pk_bf16_f32 v49, v18, v19
  v_mul_f32 v20, v84, v84
  v_mul_f32 v21, v85, v85
  v_mul_f32 v22, v86, v86
  v_mul_f32 v23, v87, v87
  v_fma_f32 v20, v20, v46, v45
  v_fma_f32 v21, v21, v46, v45
  v_fma_f32 v22, v22, v46, v45
  v_fma_f32 v23, v23, v46, v45
  global_load_dwordx4 v[220:223], v2, s[58:59] offset:1024 sc1
  v_mul_f32 v20, v20, v84
  v_mul_f32 v21, v21, v85
  v_mul_f32 v22, v22, v86
  v_mul_f32 v23, v23, v87
  v_exp_f32 v20, v20
  v_exp_f32 v21, v21
  v_exp_f32 v22, v22
  v_exp_f32 v23, v23
  v_fma_f32 v20, v20, v44, v44
  global_load_dwordx4 v[224:227], v2, s[60:61] offset:0 sc1
  v_fma_f32 v21, v21, v44, v44
  v_fma_f32 v22, v22, v44, v44
  v_fma_f32 v23, v23, v44, v44
  v_rcp_f32 v20, v20
  v_rcp_f32 v21, v21
  v_rcp_f32 v22, v22
  v_rcp_f32 v23, v23
  v_mul_f32 v20, v20, v84
  v_mul_f32 v21, v21, v85
  v_mul_f32 v22, v22, v86
  global_load_dwordx4 v[228:231], v2, s[60:61] offset:1024 sc1
  v_mul_f32 v23, v23, v87
  v_cvt_pk_bf16_f32 v50, v20, v21
  v_cvt_pk_bf16_f32 v51, v22, v23
  global_store_dwordx4 v2, v[48:51], s[4:5] offset:2048 sc1
  v_mul_f32 v16, v88, v88
  v_mul_f32 v17, v89, v89
  v_mul_f32 v18, v90, v90
  v_mul_f32 v19, v91, v91
  v_fma_f32 v16, v16, v46, v45
  global_load_dwordx4 v[232:235], v2, s[62:63] offset:0 sc1
  v_fma_f32 v17, v17, v46, v45
  v_fma_f32 v18, v18, v46, v45
  v_fma_f32 v19, v19, v46, v45
  v_mul_f32 v16, v16, v88
  v_mul_f32 v17, v17, v89
  v_mul_f32 v18, v18, v90
  v_mul_f32 v19, v19, v91
  v_exp_f32 v16, v16
  v_exp_f32 v17, v17
  v_exp_f32 v18, v18
  global_load_dwordx4 v[236:239], v2, s[62:63] offset:1024 sc1
  v_exp_f32 v19, v19
  v_fma_f32 v16, v16, v44, v44
  v_fma_f32 v17, v17, v44, v44
  v_fma_f32 v18, v18, v44, v44
  v_fma_f32 v19, v19, v44, v44
  v_rcp_f32 v16, v16
  v_rcp_f32 v17, v17
  v_rcp_f32 v18, v18
  v_rcp_f32 v19, v19
  global_load_dwordx4 v[240:243], v2, s[64:65] offset:0 sc1
  v_mul_f32 v16, v16, v88
  v_mul_f32 v17, v17, v89
  v_mul_f32 v18, v18, v90
  v_mul_f32 v19, v19, v91
  v_cvt_pk_bf16_f32 v52, v16, v17
  v_cvt_pk_bf16_f32 v53, v18, v19
  v_mul_f32 v20, v92, v92
  v_mul_f32 v21, v93, v93
  v_mul_f32 v22, v94, v94
  global_load_dwordx4 v[244:247], v2, s[64:65] offset:1024 sc1
  v_mul_f32 v23, v95, v95
  v_fma_f32 v20, v20, v46, v45
  v_fma_f32 v21, v21, v46, v45
  v_fma_f32 v22, v22, v46, v45
  v_fma_f32 v23, v23, v46, v45
  v_mul_f32 v20, v20, v92
  v_mul_f32 v21, v21, v93
  v_mul_f32 v22, v22, v94
  v_mul_f32 v23, v23, v95
  v_exp_f32 v20, v20
  global_load_dwordx4 v[248:251], v2, s[66:67] offset:0 sc1
  v_exp_f32 v21, v21
  v_exp_f32 v22, v22
  v_exp_f32 v23, v23
  v_fma_f32 v20, v20, v44, v44
  v_fma_f32 v21, v21, v44, v44
  v_fma_f32 v22, v22, v44, v44
  v_fma_f32 v23, v23, v44, v44
  v_rcp_f32 v20, v20
  v_rcp_f32 v21, v21
  global_load_dwordx4 v[252:255], v2, s[66:67] offset:1024 sc1
  v_rcp_f32 v22, v22
  v_rcp_f32 v23, v23
  v_mul_f32 v20, v20, v92
  v_mul_f32 v21, v21, v93
  v_mul_f32 v22, v22, v94
  v_mul_f32 v23, v23, v95
  v_cvt_pk_bf16_f32 v54, v20, v21
  v_cvt_pk_bf16_f32 v55, v22, v23
  global_store_dwordx4 v2, v[52:55], s[4:5] offset:3072 sc1
  s_setprio 1
  v_mfma_f32_32x32x16_bf16 v[64:79], v[96:99], v[24:27], 0
  v_mfma_f32_32x32x16_bf16 v[80:95], v[100:103], v[24:27], 0
  s_waitcnt vmcnt(13)
  v_max_u32 v11, v208, v209
  v_max3_u32 v11, v11, v210, v211
  s_waitcnt vmcnt(12)
  v_max3_u32 v11, v11, v212, v213
  v_max3_u32 v11, v11, v214, v215
  s_waitcnt vmcnt(11)
  v_max3_u32 v11, v11, v216, v217
  v_mfma_f32_32x32x16_bf16 v[64:79], v[104:107], v[28:31], v[64:79]
  v_max3_u32 v11, v11, v218, v219
  s_waitcnt vmcnt(10)
  v_max3_u32 v11, v11, v220, v221
  v_max3_u32 v11, v11, v222, v223
  s_waitcnt vmcnt(9)
  v_max3_u32 v11, v11, v224, v225
  v_mfma_f32_32x32x16_bf16 v[80:95], v[108:111], v[28:31], v[80:95]
  v_max3_u32 v11, v11, v226, v227
  s_waitcnt vmcnt(8)
  v_max3_u32 v11, v11, v228, v229
  v_max3_u32 v11, v11, v230, v231
  v_cmp_eq_u32 vcc, -1, v11
  s_cbranch_vccz Lc8
  s_mov_b32 s55, 20000
Lg00A:
  global_load_dwordx4 v[208:211], v2, s[56:57] offset:0 sc1
  global_load_dwordx4 v[212:215], v2, s[56:57] offset:1024 sc1
  global_load_dwordx4 v[216:219], v2, s[58:59] offset:0 sc1
  global_load_dwordx4 v[220:223], v2, s[58:59] offset:1024 sc1
  global_load_dwordx4 v[224:227], v2, s[60:61] offset:0 sc1
  global_load_dwordx4 v[228:231], v2, s[60:61] offset:1024 sc1
  s_waitcnt vmcnt(5)
  v_max_u32 v11, v208, v209
  v_max3_u32 v11, v11, v210, v211
  s_waitcnt vmcnt(4)
  v_max3_u32 v11, v11, v212, v213
  v_max3_u32 v11, v11, v214, v215
  s_waitcnt vmcnt(3)
  v_max3_u32 v11, v11, v216, v217
  v_max3_u32 v11, v11, v218, v219
  s_waitcnt vmcnt(2)
  v_max3_u32 v11, v11, v220, v221
  v_max3_u32 v11, v11, v222, v223
  s_waitcnt vmcnt(1)
  v_max3_u32 v11, v11, v224, v225
  v_max3_u32 v11, v11, v226, v227
  s_waitcnt vmcnt(0)
  v_max3_u32 v11, v11, v228, v229
  v_max3_u32 v11, v11, v230, v231
  v_cmp_eq_u32 vcc, -1, v11
  s_cbranch_vccz Lg00Ax
  s_sub_u32 s55, s55, 1
  s_cmp_lg_u32 s55, 0
  s_cbranch_scc1 Lg00A
Lg00Ax:
Lc8:
  v_mfma_f32_32x32x16_bf16 v[64:79], v[112:115], v[208:211], v[64:79]
  v_mfma_f32_32x32x16_bf16 v[80:95], v[116:119], v[208:211], v[80:95]
  v_mfma_f32_32x32x16_bf16 v[64:79], v[120:123], v[212:215], v[64:79]
  v_mfma_f32_32x32x16_bf16 v[80:95], v[124:127], v[212:215], v[80:95]
  v_mfma_f32_32x32x16_bf16 v[64:79], v[128:131], v[216:219], v[64:79]
  v_mfma_f32_32x32x16_bf16 v[80:95], v[132:135], v[216:219], v[80:95]
  v_mfma_f32_32x32x16_bf16 v[64:79], v[136:139], v[220:223], v[64:79]
  s_waitcnt vmcnt(6)
  v_max_u32 v11, v232, v233
  v_max3_u32 v11, v11, v234, v235
  s_waitcnt vmcnt(5)
  v_max3_u32 v11, v11, v236, v237
  v_mfma_f32_32x32x16_bf16 v[80:95], v[140:143], v[220:223], v[80:95]
  v_max3_u32 v11, v11, v238, v239
  s_waitcnt vmcnt(4)
  v_max3_u32 v11, v11, v240, v241
  v_mfma_f32_32x32x16_bf16 v[64:79], v[144:147], v[224:227], v[64:79]
  v_max3_u32 v11, v11, v242, v243
  s_waitcnt vmcnt(3)
  v_max3_u32 v11, v11, v244, v245
  v_mfma_f32_32x32x16_bf16 v[80:95], v[148:151], v[224:227], v[80:95]
  v_max3_u32 v11, v11, v246, v247
  s_waitcnt vmcnt(2)
  v_max3_u32 v11, v11, v248, v249
  v_mfma_f32_32x32x16_bf16 v[64:79], v[152:155], v[228:231], v[64:79]
  v_max3_u32 v11, v11, v250, v251
  s_waitcnt vmcnt(1)
  v_max3_u32 v11, v11, v252, v253
  v_mfma_f32_32x32x16_bf16 v[80:95], v[156:159], v[228:231], v[80:95]
  v_max3_u32 v11, v11, v254, v255
  v_cmp_eq_u32 vcc, -1, v11
  s_cbranch_vccz Lc9
  s_mov_b32 s55, 20000
Lg01A:
  global_load_dwordx4 v[232:235], v2, s[62:63] offset:0 sc1
  global_load_dwordx4 v[236:239], v2, s[62:63] offset:1024 sc1
  global_load_dwordx4 v[240:243], v2, s[64:65] offset:0 sc1
  global_load_dwordx4 v[244:247], v2, s[64:65] offset:1024 sc1
  global_load_dwordx4 v[248:251], v2, s[66:67] offset:0 sc1
  global_load_dwordx4 v[252:255], v2, s[66:67] offset:1024 sc1
  s_waitcnt vmcnt(5)
  v_max_u32 v11, v232, v233
  v_max3_u32 v11, v11, v234, v235
  s_waitcnt vmcnt(4)
  v_max3_u32 v11, v11, v236, v237
  v_max3_u32 v11, v11, v238, v239
  s_waitcnt vmcnt(3)
  v_max3_u32 v11, v11, v240, v241
  v_max3_u32 v11, v11, v242, v243
  s_waitcnt vmcnt(2)
  v_max3_u32 v11, v11, v244, v245
  v_max3_u32 v11, v11, v246, v247
  s_waitcnt vmcnt(1)
  v_max3_u32 v11, v11, v248, v249
  v_max3_u32 v11, v11, v250, v251
  s_waitcnt vmcnt(0)
  v_max3_u32 v11, v11, v252, v253
  v_max3_u32 v11, v11, v254, v255
  v_cmp_eq_u32 vcc, -1, v11
  s_cbranch_vccz Lg01Ax
  s_sub_u32 s55, s55, 1
  s_cmp_lg_u32 s55, 0
  s_cbranch_scc1 Lg01A
Lg01Ax:
Lc9:
  v_mfma_f32_32x32x16_bf16 v[64:79], v[160:163], v[232:235], v[64:79]
  v_mfma_f32_32x32x16_bf16 v[80:95], v[164:167], v[232:235], v[80:95]
  v_mfma_f32_32x32x16_bf16 v[64:79], v[168:171], v[236:239], v[64:79]
  v_mfma_f32_32x32x16_bf16 v[80:95], v[172:175], v[236:239], v[80:95]
  v_mfma_f32_32x32x16_bf16 v[64:79], v[176:179], v[240:243], v[64:79]
  v_mfma_f32_32x32x16_bf16 v[80:95], v[180:183], v[240:243], v[80:95]
  v_mfma_f32_32x32x16_bf16 v[64:79], v[184:187], v[244:247], v[64:79]
  v_mfma_f32_32x32x16_bf16 v[80:95], v[188:191], v[244:247], v[80:95]
  v_mfma_f32_32x32x16_bf16 v[64:79], v[192:195], v[248:251], v[64:79]
  v_mfma_f32_32x32x16_bf16 v[80:95], v[196:199], v[248:251], v[80:95]
  v_mfma_f32_32x32x16_bf16 v[64:79], v[200:203], v[252:255], v[64:79]
  v_mfma_f32_32x32x16_bf16 v[80:95], v[204:207], v[252:255], v[80:95]
  s_setprio 0
  s_nop 9
  v_cvt_pk_bf16_f32 v16, v64, v65
  global_load_dwordx4 v[208:211], v2, s[56:57] offset:2048 sc1
  v_cvt_pk_bf16_f32 v17, v66, v67
  v_cvt_pk_bf16_f32 v18, v68, v69
  v_cvt_pk_bf16_f32 v19, v70, v71
  ds_write_b128 v6, v[16:19] offset:0
  v_cvt_pk_bf16_f32 v20, v72, v73
  global_load_dwordx4 v[212:215], v2, s[56:57] offset:3072 sc1
  v_cvt_pk_bf16_f32 v21, v74, v75
  v_cvt_pk_bf16_f32 v22, v76, v77
  v_cvt_pk_bf16_f32 v23, v78, v79
  ds_write_b128 v6, v[20:23] offset:1152
  v_cvt_pk_bf16_f32 v24, v80, v81
  global_load_dwordx4 v[216:219], v2, s[58:59] offset:2048 sc1
  v_cvt_pk_bf16_f32 v25, v82, v83
  v_cvt_pk_bf16_f32 v26, v84, v85
  v_cvt_pk_bf16_f32 v27, v86, v87
  ds_write_b128 v6, v[24:27] offset:2304
  v_cvt_pk_bf16_f32 v28, v88, v89
  global_load_dwordx4 v[220:223], v2, s[58:59] offset:3072 sc1
  v_cvt_pk_bf16_f32 v29, v90, v91
  v_cvt_pk_bf16_f32 v30, v92, v93
  v_cvt_pk_bf16_f32 v31, v94, v95
  ds_write_b128 v6, v[28:31] offset:3456
  global_load_dwordx4 v[224:227], v2, s[60:61] offset:2048 sc1
  global_load_dwordx4 v[228:231], v2, s[60:61] offset:3072 sc1
  global_load_dwordx4 v[232:235], v2, s[62:63] offset:2048 sc1
  global_load_dwordx4 v[236:239], v2, s[62:63] offset:3072 sc1
  global_load_dwordx4 v[240:243], v2, s[64:65] offset:2048 sc1
  global_load_dwordx4 v[244:247], v2, s[64:65] offset:3072 sc1
  global_load_dwordx4 v[248:251], v2, s[66:67] offset:2048 sc1
  global_load_dwordx4 v[252:255], v2, s[66:67] offset:3072 sc1
  s_setprio 1
  v_mfma_f32_32x32x16_bf16 v[64:79], v[96:99], v[48:51], 0
  v_mfma_f32_32x32x16_bf16 v[80:95], v[100:103], v[48:51], 0
  s_waitcnt vmcnt(11)
  v_max_u32 v11, v208, v209
  v_max3_u32 v11, v11, v210, v211
  s_waitcnt vmcnt(10)
  v_max3_u32 v11, v11, v212, v213
  v_max3_u32 v11, v11, v214, v215
  s_waitcnt vmcnt(9)
  v_max3_u32 v11, v11, v216, v217
  v_mfma_f32_32x32x16_bf16 v[64:79], v[104:107], v[52:55], v[64:79]
  v_max3_u32 v11, v11, v218, v219
  s_waitcnt vmcnt(8)
  v_max3_u32 v11, v11, v220, v221
  v_max3_u32 v11, v11, v222, v223
  s_waitcnt vmcnt(7)
  v_max3_u32 v11, v11, v224, v225
  v_mfma_f32_32x32x16_bf16 v[80:95], v[108:111], v[52:55], v[80:95]
  s_waitcnt lgkmcnt(0)
  s_barrier
  v_max3_u32 v11, v11, v226, v227
  s_waitcnt vmcnt(6)
  v_max3_u32 v11, v11, v228, v229
  v_max3_u32 v11, v11, v230, v231
  v_cmp_eq_u32 vcc, -1, v11
  s_cbranch_vccz Lc10
  s_mov_b32 s55, 20000
Lg10A:
  global_load_dwordx4 v[208:211], v2, s[56:57] offset:2048 sc1
  global_load_dwordx4 v[212:215], v2, s[56:57] offset:3072 sc1
  global_load_dwordx4 v[216:219], v2, s[58:59] offset:2048 sc1
  global_load_dwordx4 v[220:223], v2, s[58:59] offset:3072 sc1
  global_load_dwordx4 v[224:227], v2, s[60:61] offset:2048 sc1
  global_load_dwordx4 v[228:231], v2, s[60:61] offset:3072 sc1
  s_waitcnt vmcnt(5)
  v_max_u32 v11, v208, v209
  v_max3_u32 v11, v11, v210, v211
  s_waitcnt vmcnt(4)
  v_max3_u32 v11, v11, v212, v213
  v_max3_u32 v11, v11, v214, v215
  s_waitcnt vmcnt(3)
  v_max3_u32 v11, v11, v216, v217
  v_max3_u32 v11, v11, v218, v219
  s_waitcnt vmcnt(2)
  v_max3_u32 v11, v11, v220, v221
  v_max3_u32 v11, v11, v222, v223
  s_waitcnt vmcnt(1)
  v_max3_u32 v11, v11, v224, v225
  v_max3_u32 v11, v11, v226, v227
  s_waitcnt vmcnt(0)
  v_max3_u32 v11, v11, v228, v229
  v_max3_u32 v11, v11, v230, v231
  v_cmp_eq_u32 vcc, -1, v11
  s_cbranch_vccz Lg10Ax
  s_sub_u32 s55, s55, 1
  s_cmp_lg_u32 s55, 0
  s_cbranch_scc1 Lg10A
Lg10Ax:
Lc10:
  v_mfma_f32_32x32x16_bf16 v[64:79], v[112:115], v[208:211], v[64:79]
  v_mfma_f32_32x32x16_bf16 v[80:95], v[116:119], v[208:211], v[80:95]
  v_mfma_f32_32x32x16_bf16 v[64:79], v[120:123], v[212:215], v[64:79]
  v_mfma_f32_32x32x16_bf16 v[80:95], v[124:127], v[212:215], v[80:95]
  v_mfma_f32_32x32x16_bf16 v[64:79], v[128:131], v[216:219], v[64:79]
  v_mfma_f32_32x32x16_bf16 v[80:95], v[132:135], v[216:219], v[80:95]
  v_mfma_f32_32x32x16_bf16 v[64:79], v[136:139], v[220:223], v[64:79]
  s_waitcnt vmcnt(5)
  v_max_u32 v11, v232, v233
  v_max3_u32 v11, v11, v234, v235
  s_waitcnt vmcnt(4)
  v_max3_u32 v11, v11, v236, v237
  v_mfma_f32_32x32x16_bf16 v[80:95], v[140:143], v[220:223], v[80:95]
  v_max3_u32 v11, v11, v238, v239
  s_waitcnt vmcnt(3)
  v_max3_u32 v11, v11, v240, v241
  v_mfma_f32_32x32x16_bf16 v[64:79], v[144:147], v[224:227], v[64:79]
  v_max3_u32 v11, v11, v242, v243
  s_waitcnt vmcnt(2)
  v_max3_u32 v11, v11, v244, v245
  v_mfma_f32_32x32x16_bf16 v[80:95], v[148:151], v[224:227], v[80:95]
  v_max3_u32 v11, v11, v246, v247
  s_waitcnt vmcnt(1)
  v_max3_u32 v11, v11, v248, v249
  v_mfma_f32_32x32x16_bf16 v[64:79], v[152:155], v[228:231], v[64:79]
  v_max3_u32 v11, v11, v250, v251
  s_waitcnt vmcnt(0)
  v_max3_u32 v11, v11, v252, v253
  v_mfma_f32_32x32x16_bf16 v[80:95], v[156:159], v[228:231], v[80:95]
  v_max3_u32 v11, v11, v254, v255
  v_cmp_eq_u32 vcc, -1, v11
  s_cbranch_vccz Lc11
  s_mov_b32 s55, 20000
Lg11A:
  global_load_dwordx4 v[232:235], v2, s[62:63] offset:2048 sc1
  global_load_dwordx4 v[236:239], v2, s[62:63] offset:3072 sc1
  global_load_dwordx4 v[240:243], v2, s[64:65] offset:2048 sc1
  global_load_dwordx4 v[244:247], v2, s[64:65] offset:3072 sc1
  global_load_dwordx4 v[248:251], v2, s[66:67] offset:2048 sc1
  global_load_dwordx4 v[252:255], v2, s[66:67] offset:3072 sc1
  s_waitcnt vmcnt(5)
  v_max_u32 v11, v232, v233
  v_max3_u32 v11, v11, v234, v235
  s_waitcnt vmcnt(4)
  v_max3_u32 v11, v11, v236, v237
  v_max3_u32 v11, v11, v238, v239
  s_waitcnt vmcnt(3)
  v_max3_u32 v11, v11, v240, v241
  v_max3_u32 v11, v11, v242, v243
  s_waitcnt vmcnt(2)
  v_max3_u32 v11, v11, v244, v245
  v_max3_u32 v11, v11, v246, v247
  s_waitcnt vmcnt(1)
  v_max3_u32 v11, v11, v248, v249
  v_max3_u32 v11, v11, v250, v251
  s_waitcnt vmcnt(0)
  v_max3_u32 v11, v11, v252, v253
  v_max3_u32 v11, v11, v254, v255
  v_cmp_eq_u32 vcc, -1, v11
  s_cbranch_vccz Lg11Ax
  s_sub_u32 s55, s55, 1
  s_cmp_lg_u32 s55, 0
  s_cbranch_scc1 Lg11A
Lg11Ax:
Lc11:
  v_mfma_f32_32x32x16_bf16 v[64:79], v[160:163], v[232:235], v[64:79]
  v_mfma_f32_32x32x16_bf16 v[80:95], v[164:167], v[232:235], v[80:95]
  v_mfma_f32_32x32x16_bf16 v[64:79], v[168:171], v[236:239], v[64:79]
  v_mfma_f32_32x32x16_bf16 v[80:95], v[172:175], v[236:239], v[80:95]
  v_mfma_f32_32x32x16_bf16 v[64:79], v[176:179], v[240:243], v[64:79]
  v_mfma_f32_32x32x16_bf16 v[80:95], v[180:183], v[240:243], v[80:95]
  v_mfma_f32_32x32x16_bf16 v[64:79], v[184:187], v[244:247], v[64:79]
  v_mfma_f32_32x32x16_bf16 v[80:95], v[188:191], v[244:247], v[80:95]
  v_mfma_f32_32x32x16_bf16 v[64:79], v[192:195], v[248:251], v[64:79]
  v_mfma_f32_32x32x16_bf16 v[80:95], v[196:199], v[248:251], v[80:95]
  v_mfma_f32_32x32x16_bf16 v[64:79], v[200:203], v[252:255], v[64:79]
  v_mfma_f32_32x32x16_bf16 v[80:95], v[204:207], v[252:255], v[80:95]
  s_setprio 0
  s_nop 9
  v_cvt_pk_bf16_f32 v16, v64, v65
  v_cvt_pk_bf16_f32 v17, v66, v67
  v_cvt_pk_bf16_f32 v18, v68, v69
  v_cvt_pk_bf16_f32 v19, v70, v71
  ds_write_b128 v6, v[16:19] offset:36864
  v_cvt_pk_bf16_f32 v20, v72, v73
  v_cvt_pk_bf16_f32 v21, v74, v75
  v_cvt_pk_bf16_f32 v22, v76, v77
  v_cvt_pk_bf16_f32 v23, v78, v79
  ds_write_b128 v6, v[20:23] offset:38016
  v_cvt_pk_bf16_f32 v24, v80, v81
  v_cvt_pk_bf16_f32 v25, v82, v83
  v_cvt_pk_bf16_f32 v26, v84, v85
  v_cvt_pk_bf16_f32 v27, v86, v87
  ds_write_b128 v6, v[24:27] offset:39168
  v_cvt_pk_bf16_f32 v28, v88, v89
  v_cvt_pk_bf16_f32 v29, v90, v91
  v_cvt_pk_bf16_f32 v30, v92, v93
  v_cvt_pk_bf16_f32 v31, v94, v95
  ds_write_b128 v6, v[28:31] offset:40320
  ds_read_b128 v[80:83], v7 offset:29184
  v_lshlrev_b32 v64, 16, v40
  v_and_b32 v65, 0xffff0000, v40
  v_lshlrev_b32 v66, 16, v41
  v_and_b32 v67, 0xffff0000, v41
  v_lshlrev_b32 v68, 16, v42
  v_and_b32 v69, 0xffff0000, v42
  v_lshlrev_b32 v70, 16, v43
  v_and_b32 v71, 0xffff0000, v43
  s_waitcnt lgkmcnt(0)
  v_lshlrev_b32 v84, 16, v80
  v_and_b32 v85, 0xffff0000, v80
  v_add_f32 v64, v64, v84
  v_add_f32 v65, v65, v85
  v_lshlrev_b32 v86, 16, v81
  v_and_b32 v87, 0xffff0000, v81
  v_add_f32 v66, v66, v86
  v_add_f32 v67, v67, v87
  v_lshlrev_b32 v84, 16, v82
  v_and_b32 v85, 0xffff0000, v82
  v_add_f32 v68, v68, v84
  v_add_f32 v69, v69, v85
  v_lshlrev_b32 v86, 16, v83
  v_and_b32 v87, 0xffff0000, v83
  v_add_f32 v70, v70, v86
  v_add_f32 v71, v71, v87
  s_barrier
  ds_read_b128 v[16:19], v39 offset:36864
  ds_read_b128 v[20:23], v39 offset:41472
  ds_read_b128 v[24:27], v39 offset:46080
  ds_read_b128 v[28:31], v39 offset:50688
  v_add_u32 v39, 126976, v39
  s_waitcnt lgkmcnt(3)
  v_lshlrev_b32 v84, 16, v16
  v_and_b32 v85, 0xffff0000, v16
  v_add_f32 v64, v64, v84
  v_add_f32 v65, v65, v85
  v_lshlrev_b32 v86, 16, v17
  v_and_b32 v87, 0xffff0000, v17
  v_add_f32 v66, v66, v86
  v_add_f32 v67, v67, v87
  v_lshlrev_b32 v84, 16, v18
  v_and_b32 v85, 0xffff0000, v18
  v_add_f32 v68, v68, v84
  v_add_f32 v69, v69, v85
  v_lshlrev_b32 v86, 16, v19
  v_and_b32 v87, 0xffff0000, v19
  v_add_f32 v70, v70, v86
  v_add_f32 v71, v71, v87
  s_waitcnt lgkmcnt(2)
  v_lshlrev_b32 v84, 16, v20
  v_and_b32 v85, 0xffff0000, v20
  v_add_f32 v64, v64, v84
  v_add_f32 v65, v65, v85
  v_lshlrev_b32 v86, 16, v21
  v_and_b32 v87, 0xffff0000, v21
  v_add_f32 v66, v66, v86
  v_add_f32 v67, v67, v87
  v_lshlrev_b32 v84, 16, v22
  v_and_b32 v85, 0xffff0000, v22
  v_add_f32 v68, v68, v84
  v_add_f32 v69, v69, v85
  v_lshlrev_b32 v86, 16, v23
  v_and_b32 v87, 0xffff0000, v23
  v_add_f32 v70, v70, v86
  v_add_f32 v71, v71, v87
  s_waitcnt lgkmcnt(1)
  v_lshlrev_b32 v84, 16, v24
  v_and_b32 v85, 0xffff0000, v24
  v_add_f32 v64, v64, v84
  v_add_f32 v65, v65, v85
  v_lshlrev_b32 v86, 16, v25
  v_and_b32 v87, 0xffff0000, v25
  v_add_f32 v66, v66, v86
  v_add_f32 v67, v67, v87
  v_lshlrev_b32 v84, 16, v26
  v_and_b32 v85, 0xffff0000, v26
  v_add_f32 v68, v68, v84
  v_add_f32 v69, v69, v85
  v_lshlrev_b32 v86, 16, v27
  v_and_b32 v87, 0xffff0000, v27
  v_add_f32 v70, v70, v86
  v_add_f32 v71, v71, v87
  s_waitcnt lgkmcnt(0)
  v_lshlrev_b32 v84, 16, v28
  v_and_b32 v85, 0xffff0000, v28
  v_add_f32 v64, v64, v84
  v_add_f32 v65, v65, v85
  v_lshlrev_b32 v86, 16, v29
  v_and_b32 v87, 0xffff0000, v29
  v_add_f32 v66, v66, v86
  v_add_f32 v67, v67, v87
  v_lshlrev_b32 v84, 16, v30
  v_and_b32 v85, 0xffff0000, v30
  v_add_f32 v68, v68, v84
  v_add_f32 v69, v69, v85
  v_lshlrev_b32 v86, 16, v31
  v_and_b32 v87, 0xffff0000, v31
  v_add_f32 v70, v70, v86
  v_add_f32 v71, v71, v87
  s_barrier
  ds_read_b128 v[16:19], v39 offset:0
  ds_read_b128 v[20:23], v39 offset:4608
  ds_read_b128 v[24:27], v39 offset:9216
  ds_read_b128 v[28:31], v39 offset:13824
  s_waitcnt lgkmcnt(3)
  v_lshlrev_b32 v84, 16, v16
  v_and_b32 v85, 0xffff0000, v16
  v_pk_add_f32 v[64:65], v[64:65], v[84:85]
  v_lshlrev_b32 v86, 16, v17
  v_and_b32 v87, 0xffff0000, v17
  v_pk_add_f32 v[66:67], v[66:67], v[86:87]
  v_lshlrev_b32 v84, 16, v18
  v_and_b32 v85, 0xffff0000, v18
  v_pk_add_f32 v[68:69], v[68:69], v[84:85]
  v_lshlrev_b32 v86, 16, v19
  v_and_b32 v87, 0xffff0000, v19
  v_pk_add_f32 v[70:71], v[70:71], v[86:87]
  s_waitcnt lgkmcnt(2)
  v_lshlrev_b32 v84, 16, v20
  v_and_b32 v85, 0xffff0000, v20
  v_pk_add_f32 v[64:65], v[64:65], v[84:85]
  v_lshlrev_b32 v86, 16, v21
  v_and_b32 v87, 0xffff0000, v21
  v_pk_add_f32 v[66:67], v[66:67], v[86:87]
  v_lshlrev_b32 v84, 16, v22
  v_and_b32 v85, 0xffff0000, v22
  v_pk_add_f32 v[68:69], v[68:69], v[84:85]
  v_lshlrev_b32 v86, 16, v23
  v_and_b32 v87, 0xffff0000, v23
  v_pk_add_f32 v[70:71], v[70:71], v[86:87]
  s_waitcnt lgkmcnt(1)
  v_lshlrev_b32 v84, 16, v24
  v_and_b32 v85, 0xffff0000, v24
  v_pk_add_f32 v[64:65], v[64:65], v[84:85]
  v_lshlrev_b32 v86, 16, v25
  v_and_b32 v87, 0xffff0000, v25
  v_pk_add_f32 v[66:67], v[66:67], v[86:87]
  v_lshlrev_b32 v84, 16, v26
  v_and_b32 v85, 0xffff0000, v26
  v_pk_add_f32 v[68:69], v[68:69], v[84:85]
  v_lshlrev_b32 v86, 16, v27
  v_and_b32 v87, 0xffff0000, v27
  v_pk_add_f32 v[70:71], v[70:71], v[86:87]
  s_waitcnt lgkmcnt(0)
  v_lshlrev_b32 v84, 16, v28
  v_and_b32 v85, 0xffff0000, v28
  v_pk_add_f32 v[64:65], v[64:65], v[84:85]
  v_lshlrev_b32 v86, 16, v29
  v_and_b32 v87, 0xffff0000, v29
  v_pk_add_f32 v[66:67], v[66:67], v[86:87]
  v_lshlrev_b32 v84, 16, v30
  v_and_b32 v85, 0xffff0000, v30
  v_pk_add_f32 v[68:69], v[68:69], v[84:85]
  v_lshlrev_b32 v86, 16, v31
  v_and_b32 v87, 0xffff0000, v31
  v_pk_add_f32 v[70:71], v[70:71], v[86:87]
  v_cvt_pk_bf16_f32 v88, v64, v65
  v_cvt_pk_bf16_f32 v89, v66, v67
  v_cvt_pk_bf16_f32 v90, v68, v69
  v_cvt_pk_bf16_f32 v91, v70, v71
  global_store_dwordx4 v3, v[88:91], s[68:69] offset:1792 sc1
  s_endpgm
LB:
  s_setprio 0
  s_and_b32 s42, s35, 2
  s_lshl_b32 s42, s42, 3
  s_lshr_b32 s43, s40, s42
  s_lshl_b32 s43, s43, 16
  s_mov_b32 s48, 0x3fb8aa3b
  v_mov_b32 v39, s43
  v_mul_f32 v38, s48, v39
  v_fma_f32 v40, s48, v39, -v38
  v_fmac_f32 v40, 0x32a57060, v39
  v_exp_f32 v38, v38
  v_mul_f32 v40, 0x3f317218, v40
  v_fmac_f32 v38, v38, v40
  v_cvt_pk_bf16_f32 v38, v38, v38
  v_and_b32 v38, 0xffff0000, v38
  s_and_b32 s42, s35, 3
  s_mul_i32 s42, s42, 30208
  s_add_u32 s54, s42, 16896
  v_lshl_add_u32 v33, v1, 3, s54
  v_lshlrev_b32 v34, 16, v29
  v_and_b32 v35, 0xffff0000, v29
  v_mul_f32 v34, s48, v34
  v_mul_f32 v35, s48, v35
  v_exp_f32 v34, v34
  v_exp_f32 v35, v35
  v_lshlrev_b32 v36, 16, v30
  v_and_b32 v37, 0xffff0000, v30
  v_cvt_pk_bf16_f32 v35, v34, v35
  v_mul_f32 v36, v38, v36
  v_mul_f32 v37, v38, v37
  v_lshlrev_b32 v34, 16, v35
  v_and_b32 v35, 0xffff0000, v35
  v_mul_f32 v34, v38, v34
  v_mul_f32 v35, v38, v35
  v_mul_f32 v36, 0xbe22f983, v36
  v_mul_f32 v37, 0xbe22f983, v37
  v_mul_f32 v34, 0xbfb8aa3b, v34
  v_mul_f32 v35, 0xbfb8aa3b, v35
  v_mul_f32 v60, 0x3f800000, v34
  v_mul_f32 v61, 0x3f800000, v35
  v_mul_f32 v62, 0x3f800000, v36
  v_mul_f32 v63, 0x3f800000, v37
  v_exp_f32 v60, v60
  v_exp_f32 v61, v61
  v_fract_f32 v62, v62
  v_fract_f32 v63, v63
  v_cos_f32 v40, v62
  v_cos_f32 v41, v63
  v_sin_f32 v42, v62
  v_sin_f32 v43, v63
  v_pk_mul_f32 v[40:41], v[40:41], v[60:61]
  v_pk_mul_f32 v[42:43], v[42:43], v[60:61]
  v_mul_f32 v60, 0x43800000, v34
  v_mul_f32 v61, 0x43800000, v35
  v_mul_f32 v62, 0x43800000, v36
  v_mul_f32 v63, 0x43800000, v37
  v_exp_f32 v60, v60
  v_exp_f32 v61, v61
  v_fract_f32 v62, v62
  v_fract_f32 v63, v63
  v_cos_f32 v44, v62
  v_cos_f32 v45, v63
  v_sin_f32 v46, v62
  v_sin_f32 v47, v63
  v_pk_mul_f32 v[44:45], v[44:45], v[60:61]
  v_pk_mul_f32 v[46:47], v[46:47], v[60:61]
  v_add_f32 v38, v38, v38
  v_lshlrev_b32 v48, 16, v31
  v_and_b32 v49, 0xffff0000, v31
  v_lshlrev_b32 v50, 16, v32
  v_and_b32 v51, 0xffff0000, v32
  v_mul_f32 v48, v38, v48
  v_mul_f32 v49, v38, v49
  v_mul_f32 v50, -v38, v50
  v_mul_f32 v51, -v38, v51
  v_pk_mul_f32 v[60:61], v[48:49], v[44:45]
  v_pk_mul_f32 v[62:63], v[48:49], v[46:47]
  v_pk_fma_f32 v[52:53], v[50:51], v[46:47], v[60:61] neg_lo:[1,0,0] neg_hi:[1,0,0]
  v_pk_fma_f32 v[54:55], v[50:51], v[44:45], v[62:63]
  v_cvt_pk_bf16_f32 v130, v48, v49
  v_cvt_pk_bf16_f32 v136, v52, v53
  v_cvt_pk_bf16_f32 v131, v50, v51
  v_cvt_pk_bf16_f32 v137, v54, v55
  ds_write_b64 v33, v[130:131] offset:0
  ds_write_b64 v33, v[136:137] offset:4224
  v_pk_mul_f32 v[56:57], v[48:49], v[40:41]
  v_pk_mul_f32 v[60:61], v[52:53], v[44:45]
  v_pk_mul_f32 v[58:59], v[48:49], v[42:43]
  v_pk_mul_f32 v[62:63], v[52:53], v[46:47]
  v_pk_fma_f32 v[48:49], v[50:51], v[42:43], v[56:57] neg_lo:[1,0,0] neg_hi:[1,0,0]
  v_pk_fma_f32 v[52:53], v[54:55], v[46:47], v[60:61] neg_lo:[1,0,0] neg_hi:[1,0,0]
  v_pk_fma_f32 v[50:51], v[50:51], v[40:41], v[58:59]
  v_pk_fma_f32 v[54:55], v[54:55], v[44:45], v[62:63]
  v_cvt_pk_bf16_f32 v132, v48, v49
  v_cvt_pk_bf16_f32 v138, v52, v53
  v_cvt_pk_bf16_f32 v133, v50, v51
  v_cvt_pk_bf16_f32 v139, v54, v55
  ds_write_b64 v33, v[132:133] offset:528
  ds_write_b64 v33, v[138:139] offset:5280
  v_pk_mul_f32 v[56:57], v[48:49], v[40:41]
  v_pk_mul_f32 v[60:61], v[52:53], v[44:45]
  v_pk_mul_f32 v[58:59], v[48:49], v[42:43]
  v_pk_mul_f32 v[62:63], v[52:53], v[46:47]
  v_pk_fma_f32 v[48:49], v[50:51], v[42:43], v[56:57] neg_lo:[1,0,0] neg_hi:[1,0,0]
  v_pk_fma_f32 v[52:53], v[54:55], v[46:47], v[60:61] neg_lo:[1,0,0] neg_hi:[1,0,0]
  v_pk_fma_f32 v[50:51], v[50:51], v[40:41], v[58:59]
  v_pk_fma_f32 v[54:55], v[54:55], v[44:45], v[62:63]
  v_cvt_pk_bf16_f32 v128, v48, v49
  v_cvt_pk_bf16_f32 v134, v52, v53
  v_cvt_pk_bf16_f32 v129, v50, v51
  v_cvt_pk_bf16_f32 v135, v54, v55
  ds_write_b64 v33, v[128:129] offset:1056
  ds_write_b64 v33, v[134:135] offset:5808
  v_pk_mul_f32 v[56:57], v[48:49], v[44:45]
  v_pk_mul_f32 v[60:61], v[52:53], v[44:45]
  v_pk_mul_f32 v[58:59], v[48:49], v[46:47]
  v_pk_mul_f32 v[62:63], v[52:53], v[46:47]
  v_pk_fma_f32 v[124:125], v[50:51], v[46:47], v[56:57] neg_lo:[1,0,0] neg_hi:[1,0,0]
  v_pk_fma_f32 v[52:53], v[54:55], v[46:47], v[60:61] neg_lo:[1,0,0] neg_hi:[1,0,0]
  v_pk_fma_f32 v[126:127], v[50:51], v[44:45], v[58:59]
  v_pk_fma_f32 v[54:55], v[54:55], v[44:45], v[62:63]
  v_cvt_pk_bf16_f32 v130, v124, v125
  v_cvt_pk_bf16_f32 v136, v52, v53
  v_cvt_pk_bf16_f32 v131, v126, v127
  v_cvt_pk_bf16_f32 v137, v54, v55
  ds_write_b64 v33, v[130:131] offset:4752
  ds_write_b64 v33, v[136:137] offset:8448
  v_pk_mul_f32 v[56:57], v[48:49], v[40:41]
  v_pk_mul_f32 v[60:61], v[52:53], v[44:45]
  v_pk_mul_f32 v[58:59], v[48:49], v[42:43]
  v_pk_mul_f32 v[62:63], v[52:53], v[46:47]
  v_pk_fma_f32 v[48:49], v[50:51], v[42:43], v[56:57] neg_lo:[1,0,0] neg_hi:[1,0,0]
  v_pk_fma_f32 v[52:53], v[54:55], v[46:47], v[60:61] neg_lo:[1,0,0] neg_hi:[1,0,0]
  v_pk_fma_f32 v[50:51], v[50:51], v[40:41], v[58:59]
  v_pk_fma_f32 v[54:55], v[54:55], v[44:45], v[62:63]
  v_cvt_pk_bf16_f32 v132, v48, v49
  v_cvt_pk_bf16_f32 v138, v52, v53
  v_cvt_pk_bf16_f32 v133, v50, v51
  v_cvt_pk_bf16_f32 v139, v54, v55
  ds_write_b64 v33, v[132:133] offset:1584
  ds_write_b64 v33, v[138:139] offset:8976
  v_pk_mul_f32 v[56:57], v[48:49], v[40:41]
  v_pk_mul_f32 v[60:61], v[52:53], v[44:45]
  v_pk_mul_f32 v[58:59], v[48:49], v[42:43]
  v_pk_mul_f32 v[62:63], v[52:53], v[46:47]
  v_pk_fma_f32 v[48:49], v[50:51], v[42:43], v[56:57] neg_lo:[1,0,0] neg_hi:[1,0,0]
  v_pk_fma_f32 v[52:53], v[54:55], v[46:47], v[60:61] neg_lo:[1,0,0] neg_hi:[1,0,0]
  v_pk_fma_f32 v[50:51], v[50:51], v[40:41], v[58:59]
  s_cmp_eq_u32 s35, 7
  s_cbranch_scc0 Lc12
  s_lshl_b32 s42, s37, 13
  s_add_u32 s42, s42, 8392704
  s_add_u32 s52, s32, s42
  s_addc_u32 s53, s33, 0
  v_lshlrev_b32 v17, 4, v1
  v_mov_b32 v20, -1
  v_mov_b32 v21, -1
  v_mov_b32 v22, -1
  v_mov_b32 v23, -1
  global_store_dwordx4 v17, v[20:23], s[52:53] offset:-4096 sc1
  global_store_dwordx4 v17, v[20:23], s[52:53] offset:-3072 sc1
  global_store_dwordx4 v17, v[20:23], s[52:53] offset:-2048 sc1
  global_store_dwordx4 v17, v[20:23], s[52:53] offset:-1024 sc1
  global_store_dwordx4 v17, v[20:23], s[52:53] offset:0 sc1
  global_store_dwordx4 v17, v[20:23], s[52:53] offset:1024 sc1
  global_store_dwordx4 v17, v[20:23], s[52:53] offset:2048 sc1
  global_store_dwordx4 v17, v[20:23], s[52:53] offset:3072 sc1
Lc12:
  v_pk_fma_f32 v[54:55], v[54:55], v[44:45], v[62:63]
  v_cvt_pk_bf16_f32 v128, v48, v49
  v_cvt_pk_bf16_f32 v134, v52, v53
  v_cvt_pk_bf16_f32 v129, v50, v51
  v_cvt_pk_bf16_f32 v135, v54, v55
  ds_write_b64 v33, v[128:129] offset:2112
  ds_write_b64 v33, v[134:135] offset:9504
  v_pk_mul_f32 v[56:57], v[48:49], v[44:45]
  v_pk_mul_f32 v[60:61], v[52:53], v[44:45]
  v_pk_mul_f32 v[58:59], v[48:49], v[46:47]
  v_pk_mul_f32 v[62:63], v[52:53], v[46:47]
  v_pk_fma_f32 v[140:141], v[50:51], v[46:47], v[56:57] neg_lo:[1,0,0] neg_hi:[1,0,0]
  v_pk_fma_f32 v[52:53], v[54:55], v[46:47], v[60:61] neg_lo:[1,0,0] neg_hi:[1,0,0]
  v_pk_fma_f32 v[142:143], v[50:51], v[44:45], v[58:59]
  v_pk_fma_f32 v[54:55], v[54:55], v[44:45], v[62:63]
  v_cvt_pk_bf16_f32 v130, v140, v141
  v_cvt_pk_bf16_f32 v136, v52, v53
  v_cvt_pk_bf16_f32 v131, v142, v143
  v_cvt_pk_bf16_f32 v137, v54, v55
  ds_write_b64 v33, v[130:131] offset:6336
  ds_write_b64 v33, v[136:137] offset:10032
  v_pk_mul_f32 v[56:57], v[48:49], v[40:41]
  v_pk_mul_f32 v[60:61], v[52:53], v[44:45]
  v_pk_mul_f32 v[58:59], v[48:49], v[42:43]
  v_pk_mul_f32 v[62:63], v[52:53], v[46:47]
  v_pk_fma_f32 v[48:49], v[50:51], v[42:43], v[56:57] neg_lo:[1,0,0] neg_hi:[1,0,0]
  v_pk_fma_f32 v[52:53], v[54:55], v[46:47], v[60:61] neg_lo:[1,0,0] neg_hi:[1,0,0]
  v_pk_fma_f32 v[50:51], v[50:51], v[40:41], v[58:59]
  v_pk_fma_f32 v[54:55], v[54:55], v[44:45], v[62:63]
  v_cvt_pk_bf16_f32 v132, v48, v49
  v_cvt_pk_bf16_f32 v138, v52, v53
  v_cvt_pk_bf16_f32 v133, v50, v51
  v_cvt_pk_bf16_f32 v139, v54, v55
  ds_write_b64 v33, v[132:133] offset:2640
  ds_write_b64 v33, v[138:139] offset:12672
  v_pk_mul_f32 v[56:57], v[48:49], v[40:41]
  v_pk_mul_f32 v[60:61], v[140:141], v[44:45]
  v_pk_mul_f32 v[58:59], v[48:49], v[42:43]
  v_pk_mul_f32 v[62:63], v[140:141], v[46:47]
  v_pk_fma_f32 v[48:49], v[50:51], v[42:43], v[56:57] neg_lo:[1,0,0] neg_hi:[1,0,0]
  v_pk_fma_f32 v[140:141], v[142:143], v[46:47], v[60:61] neg_lo:[1,0,0] neg_hi:[1,0,0]
  v_pk_fma_f32 v[50:51], v[50:51], v[40:41], v[58:59]
  v_pk_fma_f32 v[142:143], v[142:143], v[44:45], v[62:63]
  v_cvt_pk_bf16_f32 v128, v48, v49
  v_cvt_pk_bf16_f32 v134, v140, v141
  v_cvt_pk_bf16_f32 v129, v50, v51
  v_cvt_pk_bf16_f32 v135, v142, v143
  ds_write_b64 v33, v[128:129] offset:3168
  ds_write_b64 v33, v[134:135] offset:7392
  v_pk_mul_f32 v[56:57], v[48:49], v[44:45]
  v_pk_mul_f32 v[60:61], v[140:141], v[44:45]
  v_pk_mul_f32 v[58:59], v[48:49], v[46:47]
  v_pk_mul_f32 v[62:63], v[140:141], v[46:47]
  v_pk_fma_f32 v[124:125], v[50:51], v[46:47], v[56:57] neg_lo:[1,0,0] neg_hi:[1,0,0]
  v_pk_fma_f32 v[140:141], v[142:143], v[46:47], v[60:61] neg_lo:[1,0,0] neg_hi:[1,0,0]
  v_pk_fma_f32 v[126:127], v[50:51], v[44:45], v[58:59]
  v_pk_fma_f32 v[142:143], v[142:143], v[44:45], v[62:63]
  v_cvt_pk_bf16_f32 v130, v124, v125
  v_cvt_pk_bf16_f32 v136, v140, v141
  v_cvt_pk_bf16_f32 v131, v126, v127
  v_cvt_pk_bf16_f32 v137, v142, v143
  ds_write_b64 v33, v[130:131] offset:6864
  ds_write_b64 v33, v[136:137] offset:7920
  v_pk_mul_f32 v[56:57], v[48:49], v[40:41]
  v_pk_mul_f32 v[58:59], v[48:49], v[42:43]
  v_pk_fma_f32 v[48:49], v[50:51], v[42:43], v[56:57] neg_lo:[1,0,0] neg_hi:[1,0,0]
  v_pk_fma_f32 v[50:51], v[50:51], v[40:41], v[58:59]
  v_cvt_pk_bf16_f32 v132, v48, v49
  v_cvt_pk_bf16_f32 v133, v50, v51
  ds_write_b64 v33, v[132:133] offset:3696
  v_and_b32 v36, 255, v0
  v_lshrrev_b32 v37, 2, v36
  v_and_b32 v38, 3, v36
  v_mul_u32_u24 v37, 14336, v37
  v_lshl_add_u32 v37, v38, 4, v37
  v_lshlrev_b32 v38, 4, v36
  s_and_b32 s42, s37, 1
  s_mul_i32 s42, s42, 7168
  s_lshr_b32 s43, s37, 1
  s_lshl_b32 s43, s43, 6
  s_add_u32 s42, s42, s43
  s_add_u32 s42, s42, 131072
  s_add_u32 s56, s32, s42
  s_addc_u32 s57, s33, 0
  s_add_u32 s58, s56, 917504
  s_addc_u32 s59, s57, 0
  s_add_u32 s60, s58, 917504
  s_addc_u32 s61, s59, 0
  s_add_u32 s62, s60, 917504
  s_addc_u32 s63, s61, 0
  s_add_u32 s64, s32, 69632
  s_addc_u32 s65, s33, 0
  s_add_u32 s66, s32, 77824
  s_addc_u32 s67, s33, 0
  v_mov_b32 v43, v100
  s_waitcnt lgkmcnt(0)
  s_barrier
  global_load_dwordx4 v[64:67], v38, s[64:65] offset:-4096 sc1
  global_load_dwordx4 v[80:83], v37, s[56:57] sc1
  global_load_dwordx4 v[68:71], v38, s[64:65] offset:0 sc1
  global_load_dwordx4 v[84:87], v37, s[58:59] sc1
  global_load_dwordx4 v[72:75], v38, s[66:67] offset:-4096 sc1
  global_load_dwordx4 v[88:91], v37, s[60:61] sc1
  global_load_dwordx4 v[76:79], v38, s[66:67] offset:0 sc1
  s_waitcnt vmcnt(7)
  global_load_dwordx4 v[92:95], v37, s[62:63] sc1
  s_mul_i32 s42, s35, 4160
  s_add_u32 s42, s42, 108288
  v_and_b32 v11, 7, v1
  v_lshl_add_u32 v11, v11, 2, s42
  v_mov_b32 v14, 0
  v_mov_b32 v15, 0
  ds_write_b32 v11, v14
  s_and_b32 s42, s35, 1
  s_mul_i32 s42, s42, 4576
  s_add_u32 s42, s42, 137472
  v_min_u32 v11, 59, v1
  v_lshl_add_u32 v11, v11, 3, s42
  ds_write_b64 v11, v[14:15]
  s_cmp_eq_u32 s35, 7
  s_cbranch_scc0 Lc13
  s_lshl_b32 s42, s37, 5
  s_add_u32 s42, s42, s35
  s_lshl_b32 s42, s42, 2
  s_add_u32 s42, s42, 4096
  s_add_u32 s52, s32, s42
  s_addc_u32 s53, s33, 0
  v_mov_b32 v18, 0
  v_mov_b32 v19, s34
  s_waitcnt vmcnt(8)
  s_mov_b64 exec, 1
  global_store_dword v18, v19, s[52:53] sc1
  s_mov_b64 exec, -1
Lc13:
  s_waitcnt lgkmcnt(0)
  s_barrier
  ds_read2st64_b32 v[12:13], v2 offset0:0 offset1:118
  ds_read2st64_b32 v[14:15], v3 offset0:0 offset1:118
  ds_read2st64_b32 v[16:17], v4 offset0:0 offset1:118
  ds_read2st64_b32 v[18:19], v5 offset0:0 offset1:118
  ds_read2st64_b32 v[20:21], v6 offset0:0 offset1:118
  ds_read2st64_b32 v[22:23], v7 offset0:0 offset1:118
  ds_read2st64_b32 v[24:25], v8 offset0:0 offset1:118
  ds_read2st64_b32 v[26:27], v9 offset0:0 offset1:118
  ds_read2st64_b32 v[28:29], v10 offset0:0 offset1:118
  v_and_b32 v11, 255, v0
  s_lshr_b32 s42, s35, 2
  s_mul_i32 s42, s42, 8320
  s_add_u32 s42, s42, 120832
  v_cmp_ne_u32 vcc, 255, v11
  v_lshl_add_u32 v11, v11, 4, s42
  s_waitcnt lgkmcnt(8)
  v_add_f32 v12, v12, v13
  s_waitcnt lgkmcnt(7)
  v_add_f32 v14, v14, v15
  s_waitcnt lgkmcnt(6)
  v_add_f32 v16, v16, v17
  s_waitcnt lgkmcnt(5)
  v_add_f32 v18, v18, v19
  s_waitcnt lgkmcnt(4)
  v_add_f32 v20, v20, v21
  s_waitcnt lgkmcnt(3)
  v_add_f32 v22, v22, v23
  s_waitcnt lgkmcnt(2)
  v_add_f32 v24, v24, v25
  s_waitcnt lgkmcnt(1)
  v_add_f32 v26, v26, v27
  s_waitcnt lgkmcnt(0)
  v_add_f32 v28, v28, v29
  v_cndmask_b32 v28, 0, v28, vcc
  v_cvt_pk_bf16_f32 v4, v12, v14
  v_cvt_pk_bf16_f32 v5, v16, v18
  v_cvt_pk_bf16_f32 v6, v20, v22
  v_cvt_pk_bf16_f32 v7, v24, v26
  ds_write_b128 v11, v[4:7]
  v_cvt_pk_bf16_f32 v32, v14, v16
  v_cvt_pk_bf16_f32 v33, v18, v20
  v_cvt_pk_bf16_f32 v34, v22, v24
  v_cvt_pk_bf16_f32 v35, v26, v28
  ds_write_b128 v11, v[32:35] offset:4160
  s_waitcnt vmcnt(7)
  v_min_u32 v39, v65, v67
  v_max_u32 v40, v65, v67
  s_waitcnt vmcnt(6)
  v_min3_u32 v39, v39, v81, v83
  v_max3_u32 v40, v40, v81, v83
  s_waitcnt vmcnt(5)
  v_min3_u32 v39, v39, v69, v71
  v_max3_u32 v40, v40, v69, v71
  s_waitcnt vmcnt(4)
  v_min3_u32 v39, v39, v85, v87
  v_max3_u32 v40, v40, v85, v87
  s_waitcnt vmcnt(3)
  v_min3_u32 v39, v39, v73, v75
  v_max3_u32 v40, v40, v73, v75
  s_waitcnt vmcnt(2)
  v_min3_u32 v39, v39, v89, v91
  v_max3_u32 v40, v40, v89, v91
  s_waitcnt vmcnt(1)
  v_min3_u32 v39, v39, v77, v79
  v_max3_u32 v40, v40, v77, v79
  s_waitcnt vmcnt(0)
  v_min3_u32 v39, v39, v93, v95
  v_max3_u32 v40, v40, v93, v95
  v_xor_b32 v39, s34, v39
  v_xor_b32 v40, s34, v40
  v_or_b32 v39, v39, v40
  v_cmp_ne_u32 vcc, 0, v39
  s_cbranch_vccz Lc14
  s_mov_b32 s55, 20000
Lug:
  global_load_dwordx4 v[64:67], v38, s[64:65] offset:-4096 sc1
  global_load_dwordx4 v[80:83], v37, s[56:57] sc1
  global_load_dwordx4 v[68:71], v38, s[64:65] offset:0 sc1
  global_load_dwordx4 v[84:87], v37, s[58:59] sc1
  global_load_dwordx4 v[72:75], v38, s[66:67] offset:-4096 sc1
  global_load_dwordx4 v[88:91], v37, s[60:61] sc1
  global_load_dwordx4 v[76:79], v38, s[66:67] offset:0 sc1
  global_load_dwordx4 v[92:95], v37, s[62:63] sc1
  s_waitcnt vmcnt(7)
  v_min_u32 v39, v65, v67
  v_max_u32 v40, v65, v67
  s_waitcnt vmcnt(6)
  v_min3_u32 v39, v39, v81, v83
  v_max3_u32 v40, v40, v81, v83
  s_waitcnt vmcnt(5)
  v_min3_u32 v39, v39, v69, v71
  v_max3_u32 v40, v40, v69, v71
  s_waitcnt vmcnt(4)
  v_min3_u32 v39, v39, v85, v87
  v_max3_u32 v40, v40, v85, v87
  s_waitcnt vmcnt(3)
  v_min3_u32 v39, v39, v73, v75
  v_max3_u32 v40, v40, v73, v75
  s_waitcnt vmcnt(2)
  v_min3_u32 v39, v39, v89, v91
  v_max3_u32 v40, v40, v89, v91
  s_waitcnt vmcnt(1)
  v_min3_u32 v39, v39, v77, v79
  v_max3_u32 v40, v40, v77, v79
  s_waitcnt vmcnt(0)
  v_min3_u32 v39, v39, v93, v95
  v_max3_u32 v40, v40, v93, v95
  v_xor_b32 v39, s34, v39
  v_xor_b32 v40, s34, v40
  v_or_b32 v39, v39, v40
  v_cmp_ne_u32 vcc, 0, v39
  s_cbranch_vccz Lugx
  s_sub_u32 s55, s55, 1
  s_cmp_lg_u32 s55, 0
  s_cbranch_scc1 Lug
Lugx:
Lc14:
  v_lshlrev_b32 v36, 2, v36
  v_add_u32 v39, 137952, v36
  v_and_b32 v65, 0xffff0000, v64
  v_lshlrev_b32 v64, 16, v64
  v_rcp_f32 v65, v65
  v_lshlrev_b32 v96, 16, v80
  v_and_b32 v97, 0xffff0000, v80
  v_pk_add_f32 v[112:113], v[96:97], v[64:65] op_sel_hi:[1,0] neg_lo:[0,1] neg_hi:[0,1]
  v_pk_mul_f32 v[112:113], v[112:113], v[64:65] op_sel:[0,1]
  v_and_b32 v67, 0xffff0000, v66
  v_lshlrev_b32 v66, 16, v66
  v_rcp_f32 v67, v67
  v_lshlrev_b32 v98, 16, v82
  v_and_b32 v99, 0xffff0000, v82
  v_pk_add_f32 v[114:115], v[98:99], v[66:67] op_sel_hi:[1,0] neg_lo:[0,1] neg_hi:[0,1]
  v_pk_mul_f32 v[114:115], v[114:115], v[66:67] op_sel:[0,1]
  v_cvt_pk_bf16_f32 v48, v112, v114
  v_cvt_pk_bf16_f32 v49, v113, v115
  ds_write_b32 v39, v48 offset:0
  ds_write_b32 v39, v49 offset:4576
  v_and_b32 v69, 0xffff0000, v68
  v_lshlrev_b32 v68, 16, v68
  v_rcp_f32 v69, v69
  v_lshlrev_b32 v100, 16, v84
  v_and_b32 v101, 0xffff0000, v84
  v_pk_add_f32 v[116:117], v[100:101], v[68:69] op_sel_hi:[1,0] neg_lo:[0,1] neg_hi:[0,1]
  v_pk_mul_f32 v[116:117], v[116:117], v[68:69] op_sel:[0,1]
  v_and_b32 v71, 0xffff0000, v70
  v_lshlrev_b32 v70, 16, v70
  v_rcp_f32 v71, v71
  v_lshlrev_b32 v102, 16, v86
  v_and_b32 v103, 0xffff0000, v86
  v_pk_add_f32 v[118:119], v[102:103], v[70:71] op_sel_hi:[1,0] neg_lo:[0,1] neg_hi:[0,1]
  v_pk_mul_f32 v[118:119], v[118:119], v[70:71] op_sel:[0,1]
  v_cvt_pk_bf16_f32 v50, v116, v118
  v_cvt_pk_bf16_f32 v51, v117, v119
  ds_write_b32 v39, v50 offset:1024
  ds_write_b32 v39, v51 offset:5600
  v_and_b32 v73, 0xffff0000, v72
  v_lshlrev_b32 v72, 16, v72
  v_rcp_f32 v73, v73
  v_lshlrev_b32 v104, 16, v88
  v_and_b32 v105, 0xffff0000, v88
  v_pk_add_f32 v[120:121], v[104:105], v[72:73] op_sel_hi:[1,0] neg_lo:[0,1] neg_hi:[0,1]
  v_pk_mul_f32 v[120:121], v[120:121], v[72:73] op_sel:[0,1]
  v_and_b32 v75, 0xffff0000, v74
  v_lshlrev_b32 v74, 16, v74
  v_rcp_f32 v75, v75
  v_lshlrev_b32 v106, 16, v90
  v_and_b32 v107, 0xffff0000, v90
  v_pk_add_f32 v[122:123], v[106:107], v[74:75] op_sel_hi:[1,0] neg_lo:[0,1] neg_hi:[0,1]
  v_pk_mul_f32 v[122:123], v[122:123], v[74:75] op_sel:[0,1]
  v_cvt_pk_bf16_f32 v52, v120, v122
  v_cvt_pk_bf16_f32 v53, v121, v123
  ds_write_b32 v39, v52 offset:2048
  ds_write_b32 v39, v53 offset:6624
  v_and_b32 v77, 0xffff0000, v76
  v_lshlrev_b32 v76, 16, v76
  v_rcp_f32 v77, v77
  v_lshlrev_b32 v108, 16, v92
  v_and_b32 v109, 0xffff0000, v92
  v_pk_add_f32 v[124:125], v[108:109], v[76:77] op_sel_hi:[1,0] neg_lo:[0,1] neg_hi:[0,1]
  v_pk_mul_f32 v[124:125], v[124:125], v[76:77] op_sel:[0,1]
  v_and_b32 v79, 0xffff0000, v78
  v_lshlrev_b32 v78, 16, v78
  v_rcp_f32 v79, v79
  v_lshlrev_b32 v110, 16, v94
  v_and_b32 v111, 0xffff0000, v94
  v_pk_add_f32 v[126:127], v[110:111], v[78:79] op_sel_hi:[1,0] neg_lo:[0,1] neg_hi:[0,1]
  v_pk_mul_f32 v[126:127], v[126:127], v[78:79] op_sel:[0,1]
  v_cvt_pk_bf16_f32 v54, v124, v126
  v_cvt_pk_bf16_f32 v55, v125, v127
  ds_write_b32 v39, v54 offset:3072
  ds_write_b32 v39, v55 offset:7648
  s_setprio 0
  s_waitcnt lgkmcnt(0)
  s_barrier
  v_lshrrev_b32 v58, 5, v1
  v_bfe_u32 v59, v1, 2, 2
  v_lshl_add_u32 v58, v58, 3, v59
  v_bfe_u32 v59, v1, 4, 1
  v_lshlrev_b32 v58, 6, v58
  v_lshl_add_u32 v58, v59, 5, v58
  v_and_b32 v59, 3, v1
  v_lshl_add_u32 v58, v59, 3, v58
  s_mul_i32 s17, s35, 14336
  s_add_u32 s17, s17, 4096
  v_add_u32 v58, s17, v58
  s_add_u32 m0, s17, 0
  s_nop 0
  global_load_lds_dwordx4 v43, s[14:15]
  s_add_u32 s14, s14, 57344
  s_addc_u32 s15, s15, 0
  s_add_u32 m0, s17, 1024
  s_nop 0
  global_load_lds_dwordx4 v43, s[14:15]
  s_add_u32 s14, s14, 57344
  s_addc_u32 s15, s15, 0
  s_add_u32 m0, s17, 2048
  s_nop 0
  global_load_lds_dwordx4 v43, s[14:15]
  s_add_u32 s14, s14, 57344
  s_addc_u32 s15, s15, 0
  s_add_u32 m0, s17, 3072
  s_nop 0
  global_load_lds_dwordx4 v43, s[14:15]
  s_add_u32 s14, s14, 57344
  s_addc_u32 s15, s15, 0
  s_add_u32 m0, s17, 4096
  s_nop 0
  global_load_lds_dwordx4 v43, s[14:15]
  s_add_u32 s14, s14, 57344
  s_addc_u32 s15, s15, 0
  s_add_u32 m0, s17, 5120
  s_nop 0
  global_load_lds_dwordx4 v43, s[14:15]
  s_add_u32 s14, s14, 57344
  s_addc_u32 s15, s15, 0
  s_add_u32 m0, s17, 6144
  s_nop 0
  global_load_lds_dwordx4 v43, s[14:15]
  s_add_u32 s14, s14, 57344
  s_addc_u32 s15, s15, 0
  s_add_u32 m0, s17, 7168
  s_nop 0
  global_load_lds_dwordx4 v43, s[14:15]
  s_add_u32 s14, s14, 57344
  s_addc_u32 s15, s15, 0
  s_lshl_b32 s42, s41, 16
  s_and_b32 s43, s41, 0xffff0000
  v_and_b32 v36, 255, v0
  v_lshrrev_b32 v37, 7, v36
  v_mul_u32_u24 v37, 1280, v37
  v_bfe_u32 v38, v36, 1, 2
  v_mul_u32_u24 v38, 320, v38
  v_add_u32 v37, v37, v38
  v_bfe_u32 v38, v36, 3, 4
  v_lshl_add_u32 v37, v38, 4, v37
  v_and_b32 v38, 1, v36
  v_lshl_add_u32 v37, v38, 3, v37
  v_fma_f32 v64, v112, s42, v96
  v_fma_f32 v65, v114, s42, v98
  ds_write_b64 v37, v[64:65] offset:40960
  v_fma_f32 v66, v113, s43, v97
  v_fma_f32 v67, v115, s43, v99
  ds_write_b64 v37, v[66:67] offset:51200
  v_fma_f32 v68, v116, s42, v100
  v_fma_f32 v69, v118, s42, v102
  ds_write_b64 v37, v[68:69] offset:43520
  v_fma_f32 v70, v117, s43, v101
  v_fma_f32 v71, v119, s43, v103
  ds_write_b64 v37, v[70:71] offset:53760
  v_fma_f32 v72, v120, s42, v104
  v_fma_f32 v73, v122, s42, v106
  ds_write_b64 v37, v[72:73] offset:46080
  v_fma_f32 v74, v121, s43, v105
  v_fma_f32 v75, v123, s43, v107
  ds_write_b64 v37, v[74:75] offset:56320
  v_fma_f32 v76, v124, s42, v108
  v_fma_f32 v77, v126, s42, v110
  ds_write_b64 v37, v[76:77] offset:48640
  v_fma_f32 v78, v125, s43, v109
  v_fma_f32 v79, v127, s43, v111
  ds_write_b64 v37, v[78:79] offset:58880
  v_and_b32 v38, 3, v1
  v_mul_u32_u24 v38, 320, v38
  v_lshrrev_b32 v37, 2, v1
  v_lshl_add_u32 v37, v37, 4, v38
  s_mul_i32 s43, s35, 1280
  v_add_u32 v37, s43, v37
  v_lshlrev_b32 v36, 4, v0
  s_lshl_b32 s42, s37, 13
  s_add_u32 s42, s42, 8388608
  s_add_u32 s18, s32, s42
  s_addc_u32 s19, s33, 0
  s_add_u32 m0, s17, 8192
  s_nop 0
  global_load_lds_dwordx4 v43, s[14:15]
  s_add_u32 s14, s14, 57344
  s_addc_u32 s15, s15, 0
  s_add_u32 m0, s17, 9216
  s_nop 0
  global_load_lds_dwordx4 v43, s[14:15]
  s_add_u32 s14, s14, 57344
  s_addc_u32 s15, s15, 0
  s_add_u32 m0, s17, 10240
  s_nop 0
  global_load_lds_dwordx4 v43, s[14:15]
  s_add_u32 s14, s14, 57344
  s_addc_u32 s15, s15, 0
  s_add_u32 m0, s17, 11264
  s_nop 0
  global_load_lds_dwordx4 v43, s[14:15]
  s_add_u32 s14, s14, 57344
  s_addc_u32 s15, s15, 0
  s_add_u32 m0, s17, 12288
  s_nop 0
  global_load_lds_dwordx4 v43, s[14:15]
  s_add_u32 s14, s14, 57344
  s_addc_u32 s15, s15, 0
  s_add_u32 m0, s17, 13312
  s_nop 0
  global_load_lds_dwordx4 v43, s[14:15]
  s_add_u32 s14, s14, 57344
  s_addc_u32 s15, s15, 0
  s_sub_u32 s14, s14, s3
  s_subb_u32 s15, s15, 0
  s_waitcnt vmcnt(13)
  ds_read_b64_tr_b16 v[144:145], v58 offset:0
  ds_read_b64_tr_b16 v[146:147], v58 offset:256
  s_waitcnt vmcnt(12)
  ds_read_b64_tr_b16 v[148:149], v58 offset:1024
  ds_read_b64_tr_b16 v[150:151], v58 offset:1280
  s_waitcnt lgkmcnt(2)
  s_add_u32 m0, s17, 0
  s_nop 0
  global_load_lds_dwordx4 v43, s[14:15]
  s_add_u32 s14, s14, 57344
  s_addc_u32 s15, s15, 0
  s_waitcnt vmcnt(12)
  ds_read_b64_tr_b16 v[152:153], v58 offset:2048
  ds_read_b64_tr_b16 v[154:155], v58 offset:2304
  s_waitcnt lgkmcnt(2)
  s_add_u32 m0, s17, 1024
  s_nop 0
  global_load_lds_dwordx4 v43, s[14:15]
  s_add_u32 s14, s14, 57344
  s_addc_u32 s15, s15, 0
  s_waitcnt vmcnt(12)
  ds_read_b64_tr_b16 v[156:157], v58 offset:3072
  ds_read_b64_tr_b16 v[158:159], v58 offset:3328
  s_waitcnt lgkmcnt(2)
  s_add_u32 m0, s17, 2048
  s_nop 0
  global_load_lds_dwordx4 v43, s[14:15]
  s_add_u32 s14, s14, 57344
  s_addc_u32 s15, s15, 0
  s_waitcnt vmcnt(12)
  ds_read_b64_tr_b16 v[160:161], v58 offset:4096
  ds_read_b64_tr_b16 v[162:163], v58 offset:4352
  s_waitcnt lgkmcnt(2)
  s_add_u32 m0, s17, 3072
  s_nop 0
  global_load_lds_dwordx4 v43, s[14:15]
  s_add_u32 s14, s14, 57344
  s_addc_u32 s15, s15, 0
  s_waitcnt vmcnt(12)
  ds_read_b64_tr_b16 v[164:165], v58 offset:5120
  ds_read_b64_tr_b16 v[166:167], v58 offset:5376
  s_waitcnt lgkmcnt(2)
  s_add_u32 m0, s17, 4096
  s_nop 0
  global_load_lds_dwordx4 v43, s[14:15]
  s_add_u32 s14, s14, 57344
  s_addc_u32 s15, s15, 0
  s_waitcnt vmcnt(12)
  ds_read_b64_tr_b16 v[168:169], v58 offset:6144
  ds_read_b64_tr_b16 v[170:171], v58 offset:6400
  s_waitcnt lgkmcnt(2)
  s_add_u32 m0, s17, 5120
  s_nop 0
  global_load_lds_dwordx4 v43, s[14:15]
  s_add_u32 s14, s14, 57344
  s_addc_u32 s15, s15, 0
  s_waitcnt vmcnt(12)
  ds_read_b64_tr_b16 v[172:173], v58 offset:7168
  ds_read_b64_tr_b16 v[174:175], v58 offset:7424
  s_waitcnt lgkmcnt(2)
  s_add_u32 m0, s17, 6144
  s_nop 0
  global_load_lds_dwordx4 v43, s[14:15]
  s_add_u32 s14, s14, 57344
  s_addc_u32 s15, s15, 0
  s_waitcnt vmcnt(12)
  ds_read_b64_tr_b16 v[176:177], v58 offset:8192
  ds_read_b64_tr_b16 v[178:179], v58 offset:8448
  s_waitcnt lgkmcnt(2)
  s_add_u32 m0, s17, 7168
  s_nop 0
  global_load_lds_dwordx4 v43, s[14:15]
  s_add_u32 s14, s14, 57344
  s_addc_u32 s15, s15, 0
  s_waitcnt vmcnt(12)
  ds_read_b64_tr_b16 v[180:181], v58 offset:9216
  ds_read_b64_tr_b16 v[182:183], v58 offset:9472
  s_waitcnt lgkmcnt(2)
  s_add_u32 m0, s17, 8192
  s_nop 0
  global_load_lds_dwordx4 v43, s[14:15]
  s_add_u32 s14, s14, 57344
  s_addc_u32 s15, s15, 0
  s_waitcnt vmcnt(12)
  ds_read_b64_tr_b16 v[184:185], v58 offset:10240
  ds_read_b64_tr_b16 v[186:187], v58 offset:10496
  s_waitcnt lgkmcnt(2)
  s_add_u32 m0, s17, 9216
  s_nop 0
  global_load_lds_dwordx4 v43, s[14:15]
  s_add_u32 s14, s14, 57344
  s_addc_u32 s15, s15, 0
  s_waitcnt vmcnt(12)
  ds_read_b64_tr_b16 v[188:189], v58 offset:11264
  ds_read_b64_tr_b16 v[190:191], v58 offset:11520
  s_waitcnt lgkmcnt(2)
  s_add_u32 m0, s17, 10240
  s_nop 0
  global_load_lds_dwordx4 v43, s[14:15]
  s_add_u32 s14, s14, 57344
  s_addc_u32 s15, s15, 0
  s_waitcnt vmcnt(12)
  ds_read_b64_tr_b16 v[192:193], v58 offset:12288
  ds_read_b64_tr_b16 v[194:195], v58 offset:12544
  s_waitcnt lgkmcnt(2)
  s_add_u32 m0, s17, 11264
  s_nop 0
  global_load_lds_dwordx4 v43, s[14:15]
  s_add_u32 s14, s14, 57344
  s_addc_u32 s15, s15, 0
  s_waitcnt vmcnt(12)
  ds_read_b64_tr_b16 v[196:197], v58 offset:13312
  ds_read_b64_tr_b16 v[198:199], v58 offset:13568
  s_waitcnt lgkmcnt(2)
  s_add_u32 m0, s17, 12288
  s_nop 0
  global_load_lds_dwordx4 v43, s[14:15]
  s_add_u32 s14, s14, 57344
  s_addc_u32 s15, s15, 0
  s_waitcnt vmcnt(12)
  ds_read_b64_tr_b16 v[200:201], v58 offset:0
  ds_read_b64_tr_b16 v[202:203], v58 offset:256
  s_waitcnt lgkmcnt(2)
  s_add_u32 m0, s17, 13312
  s_nop 0
  global_load_lds_dwordx4 v43, s[14:15]
  s_add_u32 s14, s14, 57344
  s_addc_u32 s15, s15, 0
  s_add_u32 s46, s32, 4124
  s_addc_u32 s47, s33, 0
  v_and_b32 v44, 255, v0
  v_min_u32 v44, 223, v44
  v_lshlrev_b32 v44, 7, v44
  global_load_dword v45, v44, s[46:47] sc1
  s_waitcnt vmcnt(13)
  ds_read_b64_tr_b16 v[204:205], v58 offset:1024
  ds_read_b64_tr_b16 v[206:207], v58 offset:1280
  s_waitcnt vmcnt(12)
  ds_read_b64_tr_b16 v[208:209], v58 offset:2048
  ds_read_b64_tr_b16 v[210:211], v58 offset:2304
  s_waitcnt vmcnt(11)
  ds_read_b64_tr_b16 v[212:213], v58 offset:3072
  ds_read_b64_tr_b16 v[214:215], v58 offset:3328
  s_waitcnt vmcnt(10)
  ds_read_b64_tr_b16 v[216:217], v58 offset:4096
  ds_read_b64_tr_b16 v[218:219], v58 offset:4352
  s_waitcnt vmcnt(9)
  ds_read_b64_tr_b16 v[220:221], v58 offset:5120
  ds_read_b64_tr_b16 v[222:223], v58 offset:5376
  s_waitcnt vmcnt(8)
  ds_read_b64_tr_b16 v[224:225], v58 offset:6144
  ds_read_b64_tr_b16 v[226:227], v58 offset:6400
  s_waitcnt vmcnt(7)
  ds_read_b64_tr_b16 v[228:229], v58 offset:7168
  ds_read_b64_tr_b16 v[230:231], v58 offset:7424
  s_waitcnt vmcnt(6)
  ds_read_b64_tr_b16 v[232:233], v58 offset:8192
  ds_read_b64_tr_b16 v[234:235], v58 offset:8448
  s_waitcnt vmcnt(5)
  ds_read_b64_tr_b16 v[236:237], v58 offset:9216
  ds_read_b64_tr_b16 v[238:239], v58 offset:9472
  s_waitcnt vmcnt(4)
  ds_read_b64_tr_b16 v[240:241], v58 offset:10240
  ds_read_b64_tr_b16 v[242:243], v58 offset:10496
  s_waitcnt vmcnt(3)
  ds_read_b64_tr_b16 v[244:245], v58 offset:11264
  ds_read_b64_tr_b16 v[246:247], v58 offset:11520
  s_waitcnt vmcnt(2)
  ds_read_b64_tr_b16 v[248:249], v58 offset:12288
  ds_read_b64_tr_b16 v[250:251], v58 offset:12544
  s_waitcnt vmcnt(1)
  ds_read_b64_tr_b16 v[252:253], v58 offset:13312
  ds_read_b64_tr_b16 v[254:255], v58 offset:13568
  s_waitcnt vmcnt(0)
  v_cmp_ne_u32 vcc, s34, v45
  s_cbranch_vccz Lc15
  s_mov_b32 s55, 20000
Lhf:
  global_load_dword v45, v44, s[46:47] sc1
  s_waitcnt vmcnt(0)
  v_cmp_ne_u32 vcc, s34, v45
  s_cbranch_vccz Lhfx
  s_sub_u32 s55, s55, 1
  s_cmp_lg_u32 s55, 0
  s_cbranch_scc1 Lhf
Lhfx:
Lc15:
  s_lshr_b32 s42, s35, 1
  s_lshl_b32 s42, s42, 7
  s_add_u32 s42, s42, 32768
  s_add_u32 s8, s32, s42
  s_addc_u32 s9, s33, 0
  v_min_u32 v44, 6, v1
  v_lshlrev_b32 v44, 9, v44
  global_load_dword v45, v44, s[8:9] sc1
  s_lshl_b32 s42, s38, 7
  s_add_u32 s42, s42, 36864
  s_add_u32 s6, s32, s42
  s_addc_u32 s7, s33, 0
  s_waitcnt lgkmcnt(0)
  s_barrier
  ds_read_b128 v[16:19], v37 offset:40960
  ds_read_b128 v[24:27], v37 offset:0
  ds_read_b128 v[48:51], v37 offset:10240
  ds_read_b128 v[20:23], v37 offset:51200
  ds_read_b128 v[28:31], v37 offset:20480
  ds_read_b128 v[52:55], v37 offset:30720
  s_waitcnt lgkmcnt(3)
  v_pk_add_f32 v[24:25], v[24:25], v[48:49]
  v_pk_add_f32 v[16:17], v[16:17], v[24:25]
  v_pk_add_f32 v[26:27], v[26:27], v[50:51]
  v_pk_add_f32 v[18:19], v[18:19], v[26:27]
  s_waitcnt lgkmcnt(0)
  v_pk_add_f32 v[28:29], v[28:29], v[52:53]
  v_pk_add_f32 v[20:21], v[20:21], v[28:29]
  v_pk_add_f32 v[30:31], v[30:31], v[54:55]
  v_pk_add_f32 v[22:23], v[22:23], v[30:31]
  v_cvt_pk_bf16_f32 v40, v16, v20
  v_cvt_pk_bf16_f32 v41, v17, v21
  v_cvt_pk_bf16_f32 v42, v18, v22
  v_cvt_pk_bf16_f32 v43, v19, v23
  global_store_dwordx4 v36, v[40:43], s[18:19] sc1
  s_lshl_b32 s42, s50, 6
  v_and_b32 v12, 31, v1
  v_lshl_add_u32 v12, v12, 1, s42
  global_load_ushort v13, v12, s[22:23]
  s_lshl_b32 s42, s39, 7
  v_and_b32 v12, 7, v1
  v_lshl_add_u32 v12, v12, 4, s42
  global_load_dwordx4 v[40:43], v12, s[26:27]
  s_mul_i32 s42, s39, 229376
  s_mul_i32 s44, s35, 28672
  s_add_u32 s44, s44, s42
  s_add_u32 s44, s44, 6291456
  s_and_b32 s54, s38, 0
  s_mul_i32 s43, s54, 12288
  s_add_u32 s46, s44, s43
  s_sub_u32 s48, s44, s43
  s_add_u32 s46, s46, 8192
  s_add_u32 s48, s48, 20480
  s_mul_i32 s54, s54, 3
  s_add_u32 s44, s32, s44
  s_addc_u32 s45, s33, 0
  s_add_u32 s46, s32, s46
  s_addc_u32 s47, s33, 0
  s_add_u32 s14, s46, 4096
  s_addc_u32 s15, s47, 0
  s_add_u32 s48, s32, s48
  s_addc_u32 s49, s33, 0
  s_add_u32 s52, s48, 4096
  s_addc_u32 s53, s49, 0
  v_lshlrev_b32 v23, 4, v1
  s_waitcnt vmcnt(3)
  v_cmp_ne_u32 vcc, s34, v45
  s_cbranch_vccz Lc16
  s_mov_b32 s55, 20000
Lf1B:
  global_load_dword v45, v44, s[8:9] sc1
  s_waitcnt vmcnt(0)
  v_cmp_ne_u32 vcc, s34, v45
  s_cbranch_vccz Lf1Bx
  s_sub_u32 s55, s55, 1
  s_cmp_lg_u32 s55, 0
  s_cbranch_scc1 Lf1B
Lf1Bx:
Lc16:
  global_load_dwordx4 v[96:99], v23, s[44:45] offset:0 sc1
  global_load_dwordx4 v[100:103], v23, s[44:45] offset:1024 sc1
  global_load_dwordx4 v[104:107], v23, s[44:45] offset:2048 sc1
  global_load_dwordx4 v[108:111], v23, s[44:45] offset:3072 sc1
  v_lshrrev_b32 v12, 4, v0
  v_and_b32 v15, 15, v0
  v_lshlrev_b32 v2, 13, v12
  v_lshl_add_u32 v2, v15, 4, v2
  v_mul_u32_u24 v14, 912, v15
  v_lshl_add_u32 v3, v12, 2, v14
  v_add_u32 v3, 61440, v3
  v_add_u32 v21, 128, v3
  v_mov_b32 v20, 0x3f803f80
  v_and_b32 v12, 31, v1
  v_lshrrev_b32 v15, 5, v1
  v_mul_u32_u24 v4, 912, v12
  v_lshl_add_u32 v4, v15, 4, v4
  v_add_u32 v4, 61440, v4
  v_mul_u32_u24 v22, 80, v12
  v_lshl_add_u32 v22, v15, 5, v22
  s_lshl_b32 s42, s35, 2
  s_add_u32 s42, s42, 120832
  v_add_u32 v22, s42, v22
  v_mul_u32_u24 v5, 80, v1
  v_add_u32 v5, 120832, v5
  s_lshl_b32 s42, s38, 8
  s_add_u32 s42, s42, 8388608
  s_add_u32 s56, s32, s42
  s_addc_u32 s57, s33, 0
  s_add_u32 s58, s56, 262144
  s_addc_u32 s59, s57, 0
  s_add_u32 s60, s58, 262144
  s_addc_u32 s61, s59, 0
  s_add_u32 s62, s60, 262144
  s_addc_u32 s63, s61, 0
  s_add_u32 s64, s62, 262144
  s_addc_u32 s65, s63, 0
  s_add_u32 s66, s64, 262144
  s_addc_u32 s67, s65, 0
  s_add_u32 s68, s66, 262144
  s_addc_u32 s69, s67, 0
  s_waitcnt vmcnt(6)
  v_mov_b32 v14, 0x3f803f80
  v_mov_b32 v16, 0
  v_mov_b32 v17, 0
  v_dot2c_f32_bf16 v16, v144, v14
  v_dot2c_f32_bf16 v17, v145, v14
  v_dot2c_f32_bf16 v16, v146, v14
  v_dot2c_f32_bf16 v17, v147, v14
  v_dot2c_f32_bf16 v16, v148, v14
  v_dot2c_f32_bf16 v17, v149, v14
  v_dot2c_f32_bf16 v16, v150, v14
  v_dot2c_f32_bf16 v17, v151, v14
  v_dot2c_f32_bf16 v16, v152, v14
  v_dot2c_f32_bf16 v17, v153, v14
  v_dot2c_f32_bf16 v16, v154, v14
  v_dot2c_f32_bf16 v17, v155, v14
  v_dot2c_f32_bf16 v16, v156, v14
  v_dot2c_f32_bf16 v17, v157, v14
  v_dot2c_f32_bf16 v16, v158, v14
  v_dot2c_f32_bf16 v17, v159, v14
  v_dot2c_f32_bf16 v16, v160, v14
  v_dot2c_f32_bf16 v17, v161, v14
  v_dot2c_f32_bf16 v16, v162, v14
  v_dot2c_f32_bf16 v17, v163, v14
  v_dot2c_f32_bf16 v16, v164, v14
  v_dot2c_f32_bf16 v17, v165, v14
  v_dot2c_f32_bf16 v16, v166, v14
  v_dot2c_f32_bf16 v17, v167, v14
  v_dot2c_f32_bf16 v16, v168, v14
  v_dot2c_f32_bf16 v17, v169, v14
  v_dot2c_f32_bf16 v16, v170, v14
  v_dot2c_f32_bf16 v17, v171, v14
  v_dot2c_f32_bf16 v16, v172, v14
  v_dot2c_f32_bf16 v17, v173, v14
  v_dot2c_f32_bf16 v16, v174, v14
  v_dot2c_f32_bf16 v17, v175, v14
  v_dot2c_f32_bf16 v16, v176, v14
  v_dot2c_f32_bf16 v17, v177, v14
  v_dot2c_f32_bf16 v16, v178, v14
  v_dot2c_f32_bf16 v17, v179, v14
  v_dot2c_f32_bf16 v16, v180, v14
  v_dot2c_f32_bf16 v17, v181, v14
  v_dot2c_f32_bf16 v16, v182, v14
  v_dot2c_f32_bf16 v17, v183, v14
  v_dot2c_f32_bf16 v16, v184, v14
  v_dot2c_f32_bf16 v17, v185, v14
  v_dot2c_f32_bf16 v16, v186, v14
  v_dot2c_f32_bf16 v17, v187, v14
  v_dot2c_f32_bf16 v16, v188, v14
  v_dot2c_f32_bf16 v17, v189, v14
  v_dot2c_f32_bf16 v16, v190, v14
  v_dot2c_f32_bf16 v17, v191, v14
  v_dot2c_f32_bf16 v16, v192, v14
  v_dot2c_f32_bf16 v17, v193, v14
  v_dot2c_f32_bf16 v16, v194, v14
  v_dot2c_f32_bf16 v17, v195, v14
  v_dot2c_f32_bf16 v16, v196, v14
  v_dot2c_f32_bf16 v17, v197, v14
  v_dot2c_f32_bf16 v16, v198, v14
  v_dot2c_f32_bf16 v17, v199, v14
  v_dot2c_f32_bf16 v16, v200, v14
  v_dot2c_f32_bf16 v17, v201, v14
  v_dot2c_f32_bf16 v16, v202, v14
  v_dot2c_f32_bf16 v17, v203, v14
  v_dot2c_f32_bf16 v16, v204, v14
  v_dot2c_f32_bf16 v17, v205, v14
  v_dot2c_f32_bf16 v16, v206, v14
  v_dot2c_f32_bf16 v17, v207, v14
  v_dot2c_f32_bf16 v16, v208, v14
  v_dot2c_f32_bf16 v17, v209, v14
  v_dot2c_f32_bf16 v16, v210, v14
  v_dot2c_f32_bf16 v17, v211, v14
  v_dot2c_f32_bf16 v16, v212, v14
  v_dot2c_f32_bf16 v17, v213, v14
  v_dot2c_f32_bf16 v16, v214, v14
  v_dot2c_f32_bf16 v17, v215, v14
  v_dot2c_f32_bf16 v16, v216, v14
  v_dot2c_f32_bf16 v17, v217, v14
  v_dot2c_f32_bf16 v16, v218, v14
  v_dot2c_f32_bf16 v17, v219, v14
  v_dot2c_f32_bf16 v16, v220, v14
  v_dot2c_f32_bf16 v17, v221, v14
  v_dot2c_f32_bf16 v16, v222, v14
  v_dot2c_f32_bf16 v17, v223, v14
  v_dot2c_f32_bf16 v16, v224, v14
  v_dot2c_f32_bf16 v17, v225, v14
  v_dot2c_f32_bf16 v16, v226, v14
  v_dot2c_f32_bf16 v17, v227, v14
  v_dot2c_f32_bf16 v16, v228, v14
  v_dot2c_f32_bf16 v17, v229, v14
  v_dot2c_f32_bf16 v16, v230, v14
  v_dot2c_f32_bf16 v17, v231, v14
  v_dot2c_f32_bf16 v16, v232, v14
  v_dot2c_f32_bf16 v17, v233, v14
  v_dot2c_f32_bf16 v16, v234, v14
  v_dot2c_f32_bf16 v17, v235, v14
  v_dot2c_f32_bf16 v16, v236, v14
  v_dot2c_f32_bf16 v17, v237, v14
  v_dot2c_f32_bf16 v16, v238, v14
  v_dot2c_f32_bf16 v17, v239, v14
  v_dot2c_f32_bf16 v16, v240, v14
  v_dot2c_f32_bf16 v17, v241, v14
  v_dot2c_f32_bf16 v16, v242, v14
  v_dot2c_f32_bf16 v17, v243, v14
  v_dot2c_f32_bf16 v16, v244, v14
  v_dot2c_f32_bf16 v17, v245, v14
  v_dot2c_f32_bf16 v16, v246, v14
  v_dot2c_f32_bf16 v17, v247, v14
  v_dot2c_f32_bf16 v16, v248, v14
  v_dot2c_f32_bf16 v17, v249, v14
  v_dot2c_f32_bf16 v16, v250, v14
  v_dot2c_f32_bf16 v17, v251, v14
  v_dot2c_f32_bf16 v16, v252, v14
  v_dot2c_f32_bf16 v17, v253, v14
  v_dot2c_f32_bf16 v16, v254, v14
  v_dot2c_f32_bf16 v17, v255, v14
  global_load_dwordx4 v[64:67], v2, s[56:57] sc1
  global_load_dwordx4 v[68:71], v2, s[58:59] sc1
  global_load_dwordx4 v[72:75], v2, s[60:61] sc1
  global_load_dwordx4 v[76:79], v2, s[62:63] sc1
  global_load_dwordx4 v[80:83], v2, s[64:65] sc1
  global_load_dwordx4 v[84:87], v2, s[66:67] sc1
  global_load_dwordx4 v[88:91], v2, s[68:69] sc1
  v_add_f32 v16, v16, v17
  v_mov_b32 v17, v16
  s_nop 1
  v_permlane32_swap_b32 v16, v17
  v_add_f32 v16, v16, v17
  v_cvt_pk_bf16_f32 v9, v16, v16
  v_and_b32 v17, 0xffff0000, v9
  v_sub_f32 v16, v16, v17
  v_cvt_pk_bf16_f32 v10, v16, 0
  s_waitcnt vmcnt(12)
  v_lshl_or_b32 v8, v13, 16, v13
  v_mov_b32 v11, 0
  v_mov_b32 v35, 0
  v_cmp_le_u32 vcc, 32, v1
  s_nop 1
  v_cndmask_b32 v32, 0, v8, vcc
  v_cndmask_b32 v33, 0, v9, vcc
  v_cndmask_b32 v34, 0, v10, vcc
  v_sub_u32 v8, v8, v32
  v_sub_u32 v9, v9, v33
  v_sub_u32 v10, v10, v34
  s_mul_i32 s42, s38, 229376
  s_lshl_b32 s43, s35, 12
  s_add_u32 s10, s42, s43
  s_add_u32 s10, s10, 10485760
  s_and_b32 s13, s38, 3
  s_mul_i32 s13, s13, 229376
  s_add_u32 s13, s13, s43
  s_add_u32 s13, s13, 4194304
  s_lshl_b32 s42, s39, 15
  s_add_u32 s42, s42, s10
  s_add_u32 s4, s32, s42
  s_addc_u32 s5, s33, 0
  v_lshrrev_b32 v12, 5, v1
  v_and_b32 v14, 31, v1
  v_mul_u32_u24 v6, 576, v12
  v_lshl_add_u32 v6, v14, 4, v6
  s_mul_i32 s11, s35, 4608
  s_add_u32 s12, s11, 108544
  v_add_u32 v6, s11, v6
  v_bfe_u32 v12, v0, 3, 5
  v_and_b32 v14, 7, v0
  v_mul_u32_u24 v39, 576, v14
  v_and_b32 v15, 31, v12
  v_lshl_add_u32 v39, v15, 4, v39
  s_lshl_b32 s42, s39, 7
  s_add_u32 s42, s42, 61440
  v_mul_u32_u24 v7, 912, v12
  v_lshl_add_u32 v7, v14, 4, v7
  v_add_u32 v7, s42, v7
  v_mov_b32 v24, 0
  v_mov_b32 v25, 0
  v_mov_b32 v26, 0
  v_mov_b32 v27, 0
  v_mov_b32 v28, 0
  v_mov_b32 v29, 0
  v_mov_b32 v30, 0
  v_mov_b32 v31, 0
  s_waitcnt vmcnt(6)
  ds_write2st64_b32 v3, v64, v65 offset0:0 offset1:57
  ds_write2st64_b32 v3, v66, v67 offset0:114 offset1:171
  v_dot2c_f32_bf16 v24, v64, v20
  v_dot2c_f32_bf16 v28, v64, v64
  v_dot2c_f32_bf16 v25, v65, v20
  v_dot2c_f32_bf16 v29, v65, v65
  v_dot2c_f32_bf16 v26, v66, v20
  v_dot2c_f32_bf16 v30, v66, v66
  v_dot2c_f32_bf16 v27, v67, v20
  v_dot2c_f32_bf16 v31, v67, v67
  v_max_u32 v12, v64, v65
  v_max3_u32 v12, v12, v66, v67
  s_waitcnt vmcnt(5)
  ds_write2st64_b32 v21, v68, v69 offset0:0 offset1:57
  ds_write2st64_b32 v21, v70, v71 offset0:114 offset1:171
  v_dot2c_f32_bf16 v24, v68, v20
  v_dot2c_f32_bf16 v28, v68, v68
  v_dot2c_f32_bf16 v25, v69, v20
  v_dot2c_f32_bf16 v29, v69, v69
  v_dot2c_f32_bf16 v26, v70, v20
  v_dot2c_f32_bf16 v30, v70, v70
  v_dot2c_f32_bf16 v27, v71, v20
  v_dot2c_f32_bf16 v31, v71, v71
  v_max3_u32 v12, v12, v68, v69
  v_max3_u32 v12, v12, v70, v71
  s_waitcnt vmcnt(4)
  ds_write2st64_b32 v3, v72, v73 offset0:1 offset1:58
  ds_write2st64_b32 v3, v74, v75 offset0:115 offset1:172
  v_dot2c_f32_bf16 v24, v72, v20
  v_dot2c_f32_bf16 v28, v72, v72
  v_dot2c_f32_bf16 v25, v73, v20
  v_dot2c_f32_bf16 v29, v73, v73
  v_dot2c_f32_bf16 v26, v74, v20
  v_dot2c_f32_bf16 v30, v74, v74
  v_dot2c_f32_bf16 v27, v75, v20
  v_dot2c_f32_bf16 v31, v75, v75
  v_max3_u32 v12, v12, v72, v73
  v_max3_u32 v12, v12, v74, v75
  s_waitcnt vmcnt(3)
  ds_write2st64_b32 v21, v76, v77 offset0:1 offset1:58
  ds_write2st64_b32 v21, v78, v79 offset0:115 offset1:172
  v_dot2c_f32_bf16 v24, v76, v20
  v_dot2c_f32_bf16 v28, v76, v76
  v_dot2c_f32_bf16 v25, v77, v20
  v_dot2c_f32_bf16 v29, v77, v77
  v_dot2c_f32_bf16 v26, v78, v20
  v_dot2c_f32_bf16 v30, v78, v78
  v_dot2c_f32_bf16 v27, v79, v20
  v_dot2c_f32_bf16 v31, v79, v79
  v_max3_u32 v12, v12, v76, v77
  v_max3_u32 v12, v12, v78, v79
  s_waitcnt vmcnt(2)
  ds_write2st64_b32 v3, v80, v81 offset0:2 offset1:59
  ds_write2st64_b32 v3, v82, v83 offset0:116 offset1:173
  v_dot2c_f32_bf16 v24, v80, v20
  v_dot2c_f32_bf16 v28, v80, v80
  v_dot2c_f32_bf16 v25, v81, v20
  v_dot2c_f32_bf16 v29, v81, v81
  v_dot2c_f32_bf16 v26, v82, v20
  v_dot2c_f32_bf16 v30, v82, v82
  v_dot2c_f32_bf16 v27, v83, v20
  v_dot2c_f32_bf16 v31, v83, v83
  v_max3_u32 v12, v12, v80, v81
  v_max3_u32 v12, v12, v82, v83
  s_waitcnt vmcnt(1)
  ds_write2st64_b32 v21, v84, v85 offset0:2 offset1:59
  ds_write2st64_b32 v21, v86, v87 offset0:116 offset1:173
  v_dot2c_f32_bf16 v24, v84, v20
  v_dot2c_f32_bf16 v28, v84, v84
  v_dot2c_f32_bf16 v25, v85, v20
  v_dot2c_f32_bf16 v29, v85, v85
  v_dot2c_f32_bf16 v26, v86, v20
  v_dot2c_f32_bf16 v30, v86, v86
  v_dot2c_f32_bf16 v27, v87, v20
  v_dot2c_f32_bf16 v31, v87, v87
  v_max3_u32 v12, v12, v84, v85
  v_max3_u32 v12, v12, v86, v87
  s_waitcnt vmcnt(0)
  ds_write2st64_b32 v3, v88, v89 offset0:3 offset1:60
  ds_write2st64_b32 v3, v90, v91 offset0:117 offset1:174
  v_dot2c_f32_bf16 v24, v88, v20
  v_dot2c_f32_bf16 v28, v88, v88
  v_dot2c_f32_bf16 v25, v89, v20
  v_dot2c_f32_bf16 v29, v89, v89
  v_dot2c_f32_bf16 v26, v90, v20
  v_dot2c_f32_bf16 v30, v90, v90
  v_dot2c_f32_bf16 v27, v91, v20
  v_dot2c_f32_bf16 v31, v91, v91
  v_max3_u32 v12, v12, v88, v89
  v_max3_u32 v12, v12, v90, v91
  v_cmp_eq_u32 vcc, -1, v12
  s_cbranch_vccz Lc17
  s_mov_b32 s55, 20000
LhgB:
  global_load_dwordx4 v[64:67], v2, s[56:57] sc1
  global_load_dwordx4 v[68:71], v2, s[58:59] sc1
  global_load_dwordx4 v[72:75], v2, s[60:61] sc1
  global_load_dwordx4 v[76:79], v2, s[62:63] sc1
  global_load_dwordx4 v[80:83], v2, s[64:65] sc1
  global_load_dwordx4 v[84:87], v2, s[66:67] sc1
  global_load_dwordx4 v[88:91], v2, s[68:69] sc1
  v_mov_b32 v24, 0
  v_mov_b32 v25, 0
  v_mov_b32 v26, 0
  v_mov_b32 v27, 0
  v_mov_b32 v28, 0
  v_mov_b32 v29, 0
  v_mov_b32 v30, 0
  v_mov_b32 v31, 0
  s_waitcnt vmcnt(6)
  ds_write2st64_b32 v3, v64, v65 offset0:0 offset1:57
  ds_write2st64_b32 v3, v66, v67 offset0:114 offset1:171
  v_dot2c_f32_bf16 v24, v64, v20
  v_dot2c_f32_bf16 v28, v64, v64
  v_dot2c_f32_bf16 v25, v65, v20
  v_dot2c_f32_bf16 v29, v65, v65
  v_dot2c_f32_bf16 v26, v66, v20
  v_dot2c_f32_bf16 v30, v66, v66
  v_dot2c_f32_bf16 v27, v67, v20
  v_dot2c_f32_bf16 v31, v67, v67
  v_max_u32 v12, v64, v65
  v_max3_u32 v12, v12, v66, v67
  s_waitcnt vmcnt(5)
  ds_write2st64_b32 v21, v68, v69 offset0:0 offset1:57
  ds_write2st64_b32 v21, v70, v71 offset0:114 offset1:171
  v_dot2c_f32_bf16 v24, v68, v20
  v_dot2c_f32_bf16 v28, v68, v68
  v_dot2c_f32_bf16 v25, v69, v20
  v_dot2c_f32_bf16 v29, v69, v69
  v_dot2c_f32_bf16 v26, v70, v20
  v_dot2c_f32_bf16 v30, v70, v70
  v_dot2c_f32_bf16 v27, v71, v20
  v_dot2c_f32_bf16 v31, v71, v71
  v_max3_u32 v12, v12, v68, v69
  v_max3_u32 v12, v12, v70, v71
  s_waitcnt vmcnt(4)
  ds_write2st64_b32 v3, v72, v73 offset0:1 offset1:58
  ds_write2st64_b32 v3, v74, v75 offset0:115 offset1:172
  v_dot2c_f32_bf16 v24, v72, v20
  v_dot2c_f32_bf16 v28, v72, v72
  v_dot2c_f32_bf16 v25, v73, v20
  v_dot2c_f32_bf16 v29, v73, v73
  v_dot2c_f32_bf16 v26, v74, v20
  v_dot2c_f32_bf16 v30, v74, v74
  v_dot2c_f32_bf16 v27, v75, v20
  v_dot2c_f32_bf16 v31, v75, v75
  v_max3_u32 v12, v12, v72, v73
  v_max3_u32 v12, v12, v74, v75
  s_waitcnt vmcnt(3)
  ds_write2st64_b32 v21, v76, v77 offset0:1 offset1:58
  ds_write2st64_b32 v21, v78, v79 offset0:115 offset1:172
  v_dot2c_f32_bf16 v24, v76, v20
  v_dot2c_f32_bf16 v28, v76, v76
  v_dot2c_f32_bf16 v25, v77, v20
  v_dot2c_f32_bf16 v29, v77, v77
  v_dot2c_f32_bf16 v26, v78, v20
  v_dot2c_f32_bf16 v30, v78, v78
  v_dot2c_f32_bf16 v27, v79, v20
  v_dot2c_f32_bf16 v31, v79, v79
  v_max3_u32 v12, v12, v76, v77
  v_max3_u32 v12, v12, v78, v79
  s_waitcnt vmcnt(2)
  ds_write2st64_b32 v3, v80, v81 offset0:2 offset1:59
  ds_write2st64_b32 v3, v82, v83 offset0:116 offset1:173
  v_dot2c_f32_bf16 v24, v80, v20
  v_dot2c_f32_bf16 v28, v80, v80
  v_dot2c_f32_bf16 v25, v81, v20
  v_dot2c_f32_bf16 v29, v81, v81
  v_dot2c_f32_bf16 v26, v82, v20
  v_dot2c_f32_bf16 v30, v82, v82
  v_dot2c_f32_bf16 v27, v83, v20
  v_dot2c_f32_bf16 v31, v83, v83
  v_max3_u32 v12, v12, v80, v81
  v_max3_u32 v12, v12, v82, v83
  s_waitcnt vmcnt(1)
  ds_write2st64_b32 v21, v84, v85 offset0:2 offset1:59
  ds_write2st64_b32 v21, v86, v87 offset0:116 offset1:173
  v_dot2c_f32_bf16 v24, v84, v20
  v_dot2c_f32_bf16 v28, v84, v84
  v_dot2c_f32_bf16 v25, v85, v20
  v_dot2c_f32_bf16 v29, v85, v85
  v_dot2c_f32_bf16 v26, v86, v20
  v_dot2c_f32_bf16 v30, v86, v86
  v_dot2c_f32_bf16 v27, v87, v20
  v_dot2c_f32_bf16 v31, v87, v87
  v_max3_u32 v12, v12, v84, v85
  v_max3_u32 v12, v12, v86, v87
  s_waitcnt vmcnt(0)
  ds_write2st64_b32 v3, v88, v89 offset0:3 offset1:60
  ds_write2st64_b32 v3, v90, v91 offset0:117 offset1:174
  v_dot2c_f32_bf16 v24, v88, v20
  v_dot2c_f32_bf16 v28, v88, v88
  v_dot2c_f32_bf16 v25, v89, v20
  v_dot2c_f32_bf16 v29, v89, v89
  v_dot2c_f32_bf16 v26, v90, v20
  v_dot2c_f32_bf16 v30, v90, v90
  v_dot2c_f32_bf16 v27, v91, v20
  v_dot2c_f32_bf16 v31, v91, v91
  v_max3_u32 v12, v12, v88, v89
  v_max3_u32 v12, v12, v90, v91
  v_cmp_eq_u32 vcc, -1, v12
  s_cbranch_vccz LhgBx
  s_sub_u32 s55, s55, 1
  s_cmp_lg_u32 s55, 0
  s_cbranch_scc1 LhgB
LhgBx:
Lc17:
  s_nop 2
  v_permlane32_swap_b32 v24, v28
  v_permlane32_swap_b32 v25, v29
  v_permlane32_swap_b32 v26, v30
  v_permlane32_swap_b32 v27, v31
  v_add_f32 v24, v24, v28
  v_add_f32 v25, v25, v29
  v_add_f32 v26, v26, v30
  v_add_f32 v27, v27, v31
  v_permlane16_swap_b32 v24, v25
  s_nop 0
  v_permlane16_swap_b32 v26, v27
  v_add_f32 v24, v24, v25
  v_add_f32 v26, v26, v27
  ds_write2st64_b32 v22, v24, v26 offset0:0 offset1:10
  s_mul_i32 s42, s51, 448
  v_subrev_u32 v3, s42, v4
  v_add_u32 v4, s42, v4
  v_lshlrev_b32 v2, 4, v1
  global_load_dword v47, v11, s[6:7] sc1
  global_load_dwordx4 v[112:115], v2, s[46:47] offset:-4096 sc1
  global_load_dwordx4 v[116:119], v2, s[46:47] offset:-3072 sc1
  global_load_dwordx4 v[120:123], v2, s[46:47] offset:-2048 sc1
  global_load_dwordx4 v[124:127], v2, s[46:47] offset:-1024 sc1
  global_load_dwordx4 v[128:131], v2, s[46:47] offset:0 sc1
  global_load_dwordx4 v[132:135], v2, s[46:47] offset:1024 sc1
  s_waitcnt lgkmcnt(0)
  s_barrier
  s_setprio 0
  ds_read_b128 v[48:51], v4 offset:0
  ds_read_b128 v[52:55], v4 offset:32
  ds_read_b128 v[56:59], v4 offset:64
  ds_read_b128 v[16:19], v5 offset:0
  ds_read_b128 v[20:23], v5 offset:16
  ds_read_b128 v[24:27], v5 offset:32
  ds_read_b128 v[28:31], v5 offset:48
  ds_read_b128 v[60:63], v4 offset:96
  s_waitcnt lgkmcnt(7)
  v_mfma_f32_32x32x16_bf16 v[64:79], v[144:147], v[48:51], 0
  global_load_dwordx4 v[136:139], v2, s[46:47] offset:2048 sc1
  s_waitcnt lgkmcnt(3)
  v_add_f32 v16, v16, v20
  s_waitcnt lgkmcnt(1)
  v_add_f32 v24, v24, v28
  v_add_f32 v17, v17, v21
  v_add_f32 v25, v25, v29
  v_add_f32 v18, v18, v22
  v_add_f32 v26, v26, v30
  v_add_f32 v19, v19, v23
  v_add_f32 v27, v27, v31
  v_add_f32 v16, v16, v18
  v_add_f32 v24, v24, v26
  v_add_f32 v17, v17, v19
  v_add_f32 v25, v25, v27
  v_add_f32 v16, v16, v17
  v_add_f32 v17, v24, v25
  v_mul_f32 v19, 0xbb124925, v16
  v_mul_f32 v17, 0x3b124925, v17
  v_fma_f32 v17, -v19, v19, v17
  v_max_f32 v17, 0, v17
  v_add_f32 v18, 0x3727c5ac, v17
  v_sqrt_f32 v18, v18
  v_cvt_pk_bf16_f32 v21, v19, v19
  v_and_b32 v21, 0xffff0000, v21
  v_cvt_pk_bf16_f32 v18, v18, v18
  v_and_b32 v18, 0xffff0000, v18
  v_rcp_f32 v20, v18
  v_sub_f32 v16, v19, v21
  v_mul_f32 v17, v17, v20
  ds_read_b128 v[48:51], v4 offset:128
  v_mfma_f32_32x32x16_bf16 v[64:79], v[148:151], v[52:55], v[64:79]
  v_cvt_pk_bf16_f32 v13, v21, v16
  v_mul_f32 v17, v17, v20
  v_cvt_pk_bf16_f32 v17, v17, v17
  v_and_b32 v17, 0xffff0000, v17
  v_add_f32 v17, 0x3727c5ac, v17
  v_sqrt_f32 v17, v17
  v_lshrrev_b32 v14, 16, v21
  v_cvt_pk_bf16_f32 v17, v17, v17
  v_and_b32 v17, 0xffff0000, v17
  v_mul_f32 v36, v18, v17
  v_rcp_f32 v20, v36
  v_cvt_pk_bf16_f32 v18, v36, v36
  v_and_b32 v18, 0xffff0000, v18
  v_sub_f32 v17, v36, v18
  v_mul_f32 v37, 0xc0135761, v20
  v_cvt_pk_bf16_f32 v12, v18, v17
  v_mov_b32 v15, 0
  v_mul_f32 v20, v20, v20
  v_mul_f32 v20, 0x3d372713, v20
  v_mul_f32 v38, v20, v37
  v_mov_b32 v44, v36
  v_mov_b32 v45, v37
  v_mov_b32 v46, v38
  v_permlane32_swap_b32 v36, v44
  v_permlane32_swap_b32 v37, v45
  v_permlane32_swap_b32 v38, v46
  ds_read_b128 v[52:55], v4 offset:160
  v_mfma_f32_32x32x16_bf16 v[64:79], v[152:155], v[56:59], v[64:79]
  global_load_dwordx4 v[140:143], v2, s[46:47] offset:3072 sc1
  ds_read_b128 v[56:59], v4 offset:192
  s_waitcnt lgkmcnt(3)
  v_mfma_f32_32x32x16_bf16 v[64:79], v[156:159], v[60:63], v[64:79]
  ds_read_b128 v[60:63], v4 offset:224
  s_waitcnt lgkmcnt(3)
  v_mfma_f32_32x32x16_bf16 v[64:79], v[160:163], v[48:51], v[64:79]
  ds_read_b128 v[48:51], v4 offset:256
  s_waitcnt lgkmcnt(3)
  v_mfma_f32_32x32x16_bf16 v[64:79], v[164:167], v[52:55], v[64:79]
  s_mov_b32 m0, s11
  s_nop 0
  global_load_lds_dwordx4 v2, s[48:49] offset:0 sc1
  ds_read_b128 v[52:55], v4 offset:288
  s_waitcnt lgkmcnt(3)
  v_mfma_f32_32x32x16_bf16 v[64:79], v[168:171], v[56:59], v[64:79]
  ds_read_b128 v[56:59], v4 offset:320
  s_waitcnt lgkmcnt(3)
  v_mfma_f32_32x32x16_bf16 v[64:79], v[172:175], v[60:63], v[64:79]
  ds_read_b128 v[60:63], v4 offset:352
  s_waitcnt lgkmcnt(3)
  v_mfma_f32_32x32x16_bf16 v[64:79], v[176:179], v[48:51], v[64:79]
  global_load_lds_dwordx4 v2, s[48:49] offset:1024 sc1
  ds_read_b128 v[48:51], v4 offset:384
  s_waitcnt lgkmcnt(3)
  v_mfma_f32_32x32x16_bf16 v[64:79], v[180:183], v[52:55], v[64:79]
  ds_read_b128 v[52:55], v4 offset:416
  s_waitcnt lgkmcnt(3)
  v_mfma_f32_32x32x16_bf16 v[64:79], v[184:187], v[56:59], v[64:79]
  ds_read_b128 v[56:59], v3 offset:448
  s_waitcnt lgkmcnt(3)
  v_mfma_f32_32x32x16_bf16 v[64:79], v[188:191], v[60:63], v[64:79]
  global_load_lds_dwordx4 v2, s[48:49] offset:2048 sc1
  ds_read_b128 v[60:63], v3 offset:480
  s_waitcnt lgkmcnt(3)
  v_mfma_f32_32x32x16_bf16 v[64:79], v[192:195], v[48:51], v[64:79]
  ds_read_b128 v[48:51], v3 offset:512
  s_waitcnt lgkmcnt(3)
  v_mfma_f32_32x32x16_bf16 v[64:79], v[196:199], v[52:55], v[64:79]
  ds_read_b128 v[52:55], v3 offset:544
  s_waitcnt lgkmcnt(3)
  v_mfma_f32_32x32x16_bf16 v[64:79], v[200:203], v[56:59], v[64:79]
  global_load_lds_dwordx4 v2, s[48:49] offset:3072 sc1
  ds_read_b128 v[56:59], v3 offset:576
  s_waitcnt lgkmcnt(3)
  v_mfma_f32_32x32x16_bf16 v[64:79], v[204:207], v[60:63], v[64:79]
  ds_read_b128 v[60:63], v3 offset:608
  s_waitcnt lgkmcnt(3)
  v_mfma_f32_32x32x16_bf16 v[64:79], v[208:211], v[48:51], v[64:79]
  s_mov_b32 m0, s12
  s_nop 0
  global_load_lds_dwordx4 v2, s[52:53] offset:0 sc1
  ds_read_b128 v[48:51], v3 offset:640
  s_waitcnt lgkmcnt(3)
  v_mfma_f32_32x32x16_bf16 v[64:79], v[212:215], v[52:55], v[64:79]
  ds_read_b128 v[52:55], v3 offset:672
  s_waitcnt lgkmcnt(3)
  v_mfma_f32_32x32x16_bf16 v[64:79], v[216:219], v[56:59], v[64:79]
  ds_read_b128 v[56:59], v3 offset:704
  s_waitcnt lgkmcnt(3)
  v_mfma_f32_32x32x16_bf16 v[64:79], v[220:223], v[60:63], v[64:79]
  global_load_lds_dwordx4 v2, s[52:53] offset:1024 sc1
  ds_read_b128 v[60:63], v3 offset:736
  s_waitcnt lgkmcnt(3)
  v_mfma_f32_32x32x16_bf16 v[64:79], v[224:227], v[48:51], v[64:79]
  ds_read_b128 v[48:51], v3 offset:768
  s_waitcnt lgkmcnt(3)
  v_mfma_f32_32x32x16_bf16 v[64:79], v[228:231], v[52:55], v[64:79]
  ds_read_b128 v[52:55], v3 offset:800
  s_waitcnt lgkmcnt(3)
  v_mfma_f32_32x32x16_bf16 v[64:79], v[232:235], v[56:59], v[64:79]
  global_load_lds_dwordx4 v2, s[52:53] offset:2048 sc1
  ds_read_b128 v[56:59], v3 offset:832
  s_waitcnt lgkmcnt(3)
  v_mfma_f32_32x32x16_bf16 v[64:79], v[236:239], v[60:63], v[64:79]
  ds_read_b128 v[60:63], v3 offset:864
  s_waitcnt lgkmcnt(3)
  v_mfma_f32_32x32x16_bf16 v[64:79], v[240:243], v[48:51], v[64:79]
  ds_read_b128 v[48:51], v4 offset:29184
  s_waitcnt lgkmcnt(3)
  v_mfma_f32_32x32x16_bf16 v[64:79], v[244:247], v[52:55], v[64:79]
  global_load_lds_dwordx4 v2, s[52:53] offset:3072 sc1
  ds_read_b128 v[52:55], v4 offset:29216
  s_waitcnt lgkmcnt(3)
  v_mfma_f32_32x32x16_bf16 v[64:79], v[248:251], v[56:59], v[64:79]
  ds_read_b128 v[56:59], v4 offset:29248
  s_waitcnt lgkmcnt(3)
  v_mfma_f32_32x32x16_bf16 v[64:79], v[252:255], v[60:63], v[64:79]
  v_mfma_f32_32x32x16_bf16 v[64:79], v[8:11], v[12:15], v[64:79]
  s_setprio 0
  s_waitcnt vmcnt(16)
  v_cmp_ne_u32 vcc, s34, v47
  s_cbranch_vccz Lc18
  s_mov_b32 s55, 20000
Lf2B:
  global_load_dword v47, v11, s[6:7] sc1
  s_waitcnt vmcnt(0)
  v_cmp_ne_u32 vcc, s34, v47
  s_cbranch_vccz Lf2Bx
  s_sub_u32 s55, s55, 1
  s_cmp_lg_u32 s55, 0
  s_cbranch_scc1 Lf2B
Lf2Bx:
Lc18:
  ds_read_b128 v[60:63], v4 offset:29280
  s_waitcnt lgkmcnt(3)
  v_mfma_f32_32x32x16_bf16 v[80:95], v[144:147], v[48:51], 0
  global_load_dwordx4 v[144:147], v2, s[14:15] offset:0 sc1
  s_nop 3
  v_mul_f32 v16, v64, v64
  v_mul_f32 v17, v65, v65
  v_mul_f32 v18, v66, v66
  v_mul_f32 v19, v67, v67
  v_fma_f32 v16, v16, v38, v37
  v_fma_f32 v17, v17, v38, v37
  v_fma_f32 v18, v18, v38, v37
  v_fma_f32 v19, v19, v38, v37
  v_mul_f32 v16, v16, v64
  v_mul_f32 v17, v17, v65
  v_mul_f32 v18, v18, v66
  v_mul_f32 v19, v19, v67
  v_exp_f32 v16, v16
  v_exp_f32 v17, v17
  v_exp_f32 v18, v18
  v_exp_f32 v19, v19
  v_fma_f32 v16, v16, v36, v36
  v_fma_f32 v17, v17, v36, v36
  v_fma_f32 v18, v18, v36, v36
  v_fma_f32 v19, v19, v36, v36
  v_rcp_f32 v16, v16
  v_rcp_f32 v17, v17
  v_rcp_f32 v18, v18
  v_rcp_f32 v19, v19
  v_mul_f32 v16, v16, v64
  v_mul_f32 v17, v17, v65
  v_mul_f32 v18, v18, v66
  v_mul_f32 v19, v19, v67
  v_cvt_pk_bf16_f32 v24, v16, v17
  v_cvt_pk_bf16_f32 v25, v18, v19
  v_mul_f32 v20, v68, v68
  v_mul_f32 v21, v69, v69
  v_mul_f32 v22, v70, v70
  v_mul_f32 v23, v71, v71
  v_fma_f32 v20, v20, v38, v37
  v_fma_f32 v21, v21, v38, v37
  v_fma_f32 v22, v22, v38, v37
  v_fma_f32 v23, v23, v38, v37
  v_mul_f32 v20, v20, v68
  v_mul_f32 v21, v21, v69
  v_mul_f32 v22, v22, v70
  v_mul_f32 v23, v23, v71
  v_exp_f32 v20, v20
  v_exp_f32 v21, v21
  v_exp_f32 v22, v22
  v_exp_f32 v23, v23
  v_fma_f32 v20, v20, v36, v36
  v_fma_f32 v21, v21, v36, v36
  v_fma_f32 v22, v22, v36, v36
  v_fma_f32 v23, v23, v36, v36
  v_rcp_f32 v20, v20
  v_rcp_f32 v21, v21
  v_rcp_f32 v22, v22
  v_rcp_f32 v23, v23
  v_mul_f32 v20, v20, v68
  v_mul_f32 v21, v21, v69
  v_mul_f32 v22, v22, v70
  v_mul_f32 v23, v23, v71
  v_cvt_pk_bf16_f32 v26, v20, v21
  v_cvt_pk_bf16_f32 v27, v22, v23
  global_store_dwordx4 v2, v[24:27], s[4:5] offset:0 sc1
  v_mul_f32 v16, v72, v72
  v_mul_f32 v17, v73, v73
  v_mul_f32 v18, v74, v74
  v_mul_f32 v19, v75, v75
  v_fma_f32 v16, v16, v38, v37
  v_fma_f32 v17, v17, v38, v37
  v_fma_f32 v18, v18, v38, v37
  v_fma_f32 v19, v19, v38, v37
  v_mul_f32 v16, v16, v72
  v_mul_f32 v17, v17, v73
  v_mul_f32 v18, v18, v74
  v_mul_f32 v19, v19, v75
  v_exp_f32 v16, v16
  v_exp_f32 v17, v17
  v_exp_f32 v18, v18
  v_exp_f32 v19, v19
  v_fma_f32 v16, v16, v36, v36
  v_fma_f32 v17, v17, v36, v36
  v_fma_f32 v18, v18, v36, v36
  v_fma_f32 v19, v19, v36, v36
  v_rcp_f32 v16, v16
  v_rcp_f32 v17, v17
  v_rcp_f32 v18, v18
  v_rcp_f32 v19, v19
  v_mul_f32 v16, v16, v72
  v_mul_f32 v17, v17, v73
  v_mul_f32 v18, v18, v74
  v_mul_f32 v19, v19, v75
  v_cvt_pk_bf16_f32 v28, v16, v17
  v_cvt_pk_bf16_f32 v29, v18, v19
  v_mul_f32 v20, v76, v76
  v_mul_f32 v21, v77, v77
  v_mul_f32 v22, v78, v78
  v_mul_f32 v23, v79, v79
  v_fma_f32 v20, v20, v38, v37
  v_fma_f32 v21, v21, v38, v37
  v_fma_f32 v22, v22, v38, v37
  v_fma_f32 v23, v23, v38, v37
  v_mul_f32 v20, v20, v76
  v_mul_f32 v21, v21, v77
  v_mul_f32 v22, v22, v78
  v_mul_f32 v23, v23, v79
  v_exp_f32 v20, v20
  v_exp_f32 v21, v21
  v_exp_f32 v22, v22
  v_exp_f32 v23, v23
  v_fma_f32 v20, v20, v36, v36
  v_fma_f32 v21, v21, v36, v36
  v_fma_f32 v22, v22, v36, v36
  v_fma_f32 v23, v23, v36, v36
  v_rcp_f32 v20, v20
  v_rcp_f32 v21, v21
  v_rcp_f32 v22, v22
  v_rcp_f32 v23, v23
  v_mul_f32 v20, v20, v76
  v_mul_f32 v21, v21, v77
  v_mul_f32 v22, v22, v78
  v_mul_f32 v23, v23, v79
  v_cvt_pk_bf16_f32 v30, v20, v21
  v_cvt_pk_bf16_f32 v31, v22, v23
  global_store_dwordx4 v2, v[28:31], s[4:5] offset:1024 sc1
  s_setprio 1
  ds_read_b128 v[48:51], v4 offset:29312
  s_waitcnt lgkmcnt(3)
  v_mfma_f32_32x32x16_bf16 v[80:95], v[148:151], v[52:55], v[80:95]
  global_load_dwordx4 v[148:151], v2, s[14:15] offset:1024 sc1
  ds_read_b128 v[52:55], v4 offset:29344
  s_waitcnt lgkmcnt(3)
  v_mfma_f32_32x32x16_bf16 v[80:95], v[152:155], v[56:59], v[80:95]
  v_add_u32 v8, s11, v2
  v_add_u32 v9, s12, v2
  ds_read_b128 v[56:59], v4 offset:29376
  s_waitcnt lgkmcnt(3)
  v_mfma_f32_32x32x16_bf16 v[80:95], v[156:159], v[60:63], v[80:95]
  global_load_dwordx4 v[152:155], v2, s[14:15] offset:2048 sc1
  ds_read_b128 v[60:63], v4 offset:29408
  s_waitcnt lgkmcnt(3)
  v_mfma_f32_32x32x16_bf16 v[80:95], v[160:163], v[48:51], v[80:95]
  global_load_dwordx4 v[156:159], v2, s[14:15] offset:3072 sc1
  ds_read_b128 v[48:51], v4 offset:29440
  s_waitcnt lgkmcnt(3)
  v_mfma_f32_32x32x16_bf16 v[80:95], v[164:167], v[52:55], v[80:95]
  ds_read_b128 v[52:55], v4 offset:29472
  s_waitcnt lgkmcnt(3)
  v_mfma_f32_32x32x16_bf16 v[80:95], v[168:171], v[56:59], v[80:95]
  global_load_dwordx4 v[160:163], v2, s[48:49] offset:-4096 sc1
  ds_read_b128 v[56:59], v4 offset:29504
  s_waitcnt lgkmcnt(3)
  v_mfma_f32_32x32x16_bf16 v[80:95], v[172:175], v[60:63], v[80:95]
  global_load_dwordx4 v[164:167], v2, s[48:49] offset:-3072 sc1
  ds_read_b128 v[60:63], v4 offset:29536
  s_waitcnt lgkmcnt(3)
  v_mfma_f32_32x32x16_bf16 v[80:95], v[176:179], v[48:51], v[80:95]
  ds_read_b128 v[48:51], v4 offset:29568
  s_waitcnt lgkmcnt(3)
  v_mfma_f32_32x32x16_bf16 v[80:95], v[180:183], v[52:55], v[80:95]
  global_load_dwordx4 v[168:171], v2, s[48:49] offset:-2048 sc1
  ds_read_b128 v[52:55], v4 offset:29600
  s_waitcnt lgkmcnt(3)
  v_mfma_f32_32x32x16_bf16 v[80:95], v[184:187], v[56:59], v[80:95]
  global_load_dwordx4 v[172:175], v2, s[48:49] offset:-1024 sc1
  ds_read_b128 v[56:59], v3 offset:29632
  s_waitcnt lgkmcnt(3)
  v_mfma_f32_32x32x16_bf16 v[80:95], v[188:191], v[60:63], v[80:95]
  ds_read_b128 v[60:63], v3 offset:29664
  s_waitcnt lgkmcnt(3)
  v_mfma_f32_32x32x16_bf16 v[80:95], v[192:195], v[48:51], v[80:95]
  s_add_u32 s42, s39, 1
  s_add_u32 s42, s42, s54
  s_cmp_ge_u32 s42, 7
  s_cselect_b32 s43, 7, 0
  s_sub_u32 s42, s42, s43
  ds_read_b128 v[48:51], v3 offset:29696
  s_waitcnt lgkmcnt(3)
  v_mfma_f32_32x32x16_bf16 v[80:95], v[196:199], v[52:55], v[80:95]
  s_lshl_b32 s42, s42, 15
  s_add_u32 s42, s42, s10
  s_add_u32 s56, s32, s42
  s_addc_u32 s57, s33, 0
  ds_read_b128 v[52:55], v3 offset:29728
  s_waitcnt lgkmcnt(3)
  v_mfma_f32_32x32x16_bf16 v[80:95], v[200:203], v[56:59], v[80:95]
  s_add_u32 s42, s39, 2
  s_add_u32 s42, s42, s54
  s_cmp_ge_u32 s42, 7
  s_cselect_b32 s43, 7, 0
  s_sub_u32 s42, s42, s43
  ds_read_b128 v[56:59], v3 offset:29760
  s_waitcnt lgkmcnt(3)
  v_mfma_f32_32x32x16_bf16 v[80:95], v[204:207], v[60:63], v[80:95]
  s_waitcnt vmcnt(10)
  s_lshl_b32 s42, s42, 15
  s_add_u32 s42, s42, s10
  s_add_u32 s58, s32, s42
  s_addc_u32 s59, s33, 0
  ds_read_b128 v[60:63], v3 offset:29792
  s_waitcnt lgkmcnt(3)
  v_mfma_f32_32x32x16_bf16 v[80:95], v[208:211], v[48:51], v[80:95]
  ds_read_b128 v[176:179], v8 offset:0
  s_add_u32 s42, s39, 3
  s_add_u32 s42, s42, s54
  s_cmp_ge_u32 s42, 7
  s_cselect_b32 s43, 7, 0
  s_sub_u32 s42, s42, s43
  ds_read_b128 v[48:51], v3 offset:29824
  s_waitcnt lgkmcnt(4)
  v_mfma_f32_32x32x16_bf16 v[80:95], v[212:215], v[52:55], v[80:95]
  ds_read_b128 v[180:183], v8 offset:1024
  ds_read_b128 v[52:55], v3 offset:29856
  s_waitcnt lgkmcnt(5)
  v_mfma_f32_32x32x16_bf16 v[80:95], v[216:219], v[56:59], v[80:95]
  ds_read_b128 v[184:187], v8 offset:2048
  s_lshl_b32 s42, s42, 15
  s_add_u32 s42, s42, s10
  s_add_u32 s60, s32, s42
  s_addc_u32 s61, s33, 0
  ds_read_b128 v[56:59], v3 offset:29888
  s_waitcnt lgkmcnt(6)
  v_mfma_f32_32x32x16_bf16 v[80:95], v[220:223], v[60:63], v[80:95]
  ds_read_b128 v[188:191], v8 offset:3072
  s_add_u32 s42, s39, 4
  s_sub_u32 s42, s42, s54
  s_cmp_ge_u32 s42, 7
  s_cselect_b32 s43, 7, 0
  s_sub_u32 s42, s42, s43
  ds_read_b128 v[60:63], v3 offset:29920
  s_waitcnt lgkmcnt(6)
  v_mfma_f32_32x32x16_bf16 v[80:95], v[224:227], v[48:51], v[80:95]
  ds_read_b128 v[192:195], v9 offset:0
  s_lshl_b32 s42, s42, 15
  s_add_u32 s42, s42, s10
  s_add_u32 s62, s32, s42
  s_addc_u32 s63, s33, 0
  ds_read_b128 v[48:51], v3 offset:29952
  s_waitcnt lgkmcnt(6)
  v_mfma_f32_32x32x16_bf16 v[80:95], v[228:231], v[52:55], v[80:95]
  ds_read_b128 v[196:199], v9 offset:1024
  s_add_u32 s42, s39, 5
  s_sub_u32 s42, s42, s54
  s_cmp_ge_u32 s42, 7
  s_cselect_b32 s43, 7, 0
  s_sub_u32 s42, s42, s43
  ds_read_b128 v[52:55], v3 offset:29984
  s_waitcnt lgkmcnt(6)
  v_mfma_f32_32x32x16_bf16 v[80:95], v[232:235], v[56:59], v[80:95]
  ds_read_b128 v[200:203], v9 offset:2048
  ds_read_b128 v[56:59], v3 offset:30016
  s_waitcnt lgkmcnt(6)
  v_mfma_f32_32x32x16_bf16 v[80:95], v[236:239], v[60:63], v[80:95]
  ds_read_b128 v[204:207], v9 offset:3072
  s_lshl_b32 s42, s42, 15
  s_add_u32 s42, s42, s10
  s_add_u32 s64, s32, s42
  s_addc_u32 s65, s33, 0
  ds_read_b128 v[60:63], v3 offset:30048
  s_waitcnt lgkmcnt(6)
  v_mfma_f32_32x32x16_bf16 v[80:95], v[240:243], v[48:51], v[80:95]
  s_add_u32 s42, s39, 6
  s_sub_u32 s42, s42, s54
  s_cmp_ge_u32 s42, 7
  s_cselect_b32 s43, 7, 0
  s_sub_u32 s42, s42, s43
  s_waitcnt lgkmcnt(4)
  v_mfma_f32_32x32x16_bf16 v[80:95], v[244:247], v[52:55], v[80:95]
  s_lshl_b32 s42, s42, 15
  s_add_u32 s42, s42, s10
  s_add_u32 s66, s32, s42
  s_addc_u32 s67, s33, 0
  s_waitcnt lgkmcnt(2)
  v_mfma_f32_32x32x16_bf16 v[80:95], v[248:251], v[56:59], v[80:95]
  s_mul_i32 s42, s38, 57344
  s_lshl_b32 s43, s39, 7
  s_add_u32 s42, s42, s43
  s_add_u32 s68, s28, s42
  s_addc_u32 s69, s29, 0
  s_waitcnt lgkmcnt(0)
  v_mfma_f32_32x32x16_bf16 v[80:95], v[252:255], v[60:63], v[80:95]
  v_mfma_f32_32x32x16_bf16 v[80:95], v[32:35], v[12:15], v[80:95]
  s_setprio 0
  v_bfe_u32 v8, v0, 3, 5
  v_and_b32 v9, 15, v8
  v_lshrrev_b32 v8, 4, v8
  v_lshl_add_u32 v8, v9, 2, v8
  v_and_b32 v9, 7, v0
  v_mul_u32_u24 v3, 896, v8
  v_lshl_add_u32 v3, v9, 4, v3
  s_nop 3
  v_mul_f32 v16, v80, v80
  v_mul_f32 v17, v81, v81
  v_mul_f32 v18, v82, v82
  v_mul_f32 v19, v83, v83
  v_fma_f32 v16, v16, v46, v45
  v_fma_f32 v17, v17, v46, v45
  v_fma_f32 v18, v18, v46, v45
  v_fma_f32 v19, v19, v46, v45
  v_mul_f32 v16, v16, v80
  v_mul_f32 v17, v17, v81
  global_load_dwordx4 v[208:211], v2, s[56:57] offset:0 sc1
  v_mul_f32 v18, v18, v82
  v_mul_f32 v19, v19, v83
  v_exp_f32 v16, v16
  v_exp_f32 v17, v17
  v_exp_f32 v18, v18
  v_exp_f32 v19, v19
  v_fma_f32 v16, v16, v44, v44
  v_fma_f32 v17, v17, v44, v44
  v_fma_f32 v18, v18, v44, v44
  global_load_dwordx4 v[212:215], v2, s[56:57] offset:1024 sc1
  v_fma_f32 v19, v19, v44, v44
  v_rcp_f32 v16, v16
  v_rcp_f32 v17, v17
  v_rcp_f32 v18, v18
  v_rcp_f32 v19, v19
  v_mul_f32 v16, v16, v80
  v_mul_f32 v17, v17, v81
  v_mul_f32 v18, v18, v82
  v_mul_f32 v19, v19, v83
  v_cvt_pk_bf16_f32 v48, v16, v17
  global_load_dwordx4 v[216:219], v2, s[58:59] offset:0 sc1
  v_cvt_pk_bf16_f32 v49, v18, v19
  v_mul_f32 v20, v84, v84
  v_mul_f32 v21, v85, v85
  v_mul_f32 v22, v86, v86
  v_mul_f32 v23, v87, v87
  v_fma_f32 v20, v20, v46, v45
  v_fma_f32 v21, v21, v46, v45
  v_fma_f32 v22, v22, v46, v45
  v_fma_f32 v23, v23, v46, v45
  global_load_dwordx4 v[220:223], v2, s[58:59] offset:1024 sc1
  v_mul_f32 v20, v20, v84
  v_mul_f32 v21, v21, v85
  v_mul_f32 v22, v22, v86
  v_mul_f32 v23, v23, v87
  v_exp_f32 v20, v20
  v_exp_f32 v21, v21
  v_exp_f32 v22, v22
  v_exp_f32 v23, v23
  v_fma_f32 v20, v20, v44, v44
  global_load_dwordx4 v[224:227], v2, s[60:61] offset:0 sc1
  v_fma_f32 v21, v21, v44, v44
  v_fma_f32 v22, v22, v44, v44
  v_fma_f32 v23, v23, v44, v44
  v_rcp_f32 v20, v20
  v_rcp_f32 v21, v21
  v_rcp_f32 v22, v22
  v_rcp_f32 v23, v23
  v_mul_f32 v20, v20, v84
  v_mul_f32 v21, v21, v85
  v_mul_f32 v22, v22, v86
  global_load_dwordx4 v[228:231], v2, s[60:61] offset:1024 sc1
  v_mul_f32 v23, v23, v87
  v_cvt_pk_bf16_f32 v50, v20, v21
  v_cvt_pk_bf16_f32 v51, v22, v23
  global_store_dwordx4 v2, v[48:51], s[4:5] offset:2048 sc1
  v_mul_f32 v16, v88, v88
  v_mul_f32 v17, v89, v89
  v_mul_f32 v18, v90, v90
  v_mul_f32 v19, v91, v91
  v_fma_f32 v16, v16, v46, v45
  global_load_dwordx4 v[232:235], v2, s[62:63] offset:0 sc1
  v_fma_f32 v17, v17, v46, v45
  v_fma_f32 v18, v18, v46, v45
  v_fma_f32 v19, v19, v46, v45
  v_mul_f32 v16, v16, v88
  v_mul_f32 v17, v17, v89
  v_mul_f32 v18, v18, v90
  v_mul_f32 v19, v19, v91
  v_exp_f32 v16, v16
  v_exp_f32 v17, v17
  v_exp_f32 v18, v18
  global_load_dwordx4 v[236:239], v2, s[62:63] offset:1024 sc1
  v_exp_f32 v19, v19
  v_fma_f32 v16, v16, v44, v44
  v_fma_f32 v17, v17, v44, v44
  v_fma_f32 v18, v18, v44, v44
  v_fma_f32 v19, v19, v44, v44
  v_rcp_f32 v16, v16
  v_rcp_f32 v17, v17
  v_rcp_f32 v18, v18
  v_rcp_f32 v19, v19
  global_load_dwordx4 v[240:243], v2, s[64:65] offset:0 sc1
  v_mul_f32 v16, v16, v88
  v_mul_f32 v17, v17, v89
  v_mul_f32 v18, v18, v90
  v_mul_f32 v19, v19, v91
  v_cvt_pk_bf16_f32 v52, v16, v17
  v_cvt_pk_bf16_f32 v53, v18, v19
  v_mul_f32 v20, v92, v92
  v_mul_f32 v21, v93, v93
  v_mul_f32 v22, v94, v94
  global_load_dwordx4 v[244:247], v2, s[64:65] offset:1024 sc1
  v_mul_f32 v23, v95, v95
  v_fma_f32 v20, v20, v46, v45
  v_fma_f32 v21, v21, v46, v45
  v_fma_f32 v22, v22, v46, v45
  v_fma_f32 v23, v23, v46, v45
  v_mul_f32 v20, v20, v92
  v_mul_f32 v21, v21, v93
  v_mul_f32 v22, v22, v94
  v_mul_f32 v23, v23, v95
  v_exp_f32 v20, v20
  global_load_dwordx4 v[248:251], v2, s[66:67] offset:0 sc1
  v_exp_f32 v21, v21
  v_exp_f32 v22, v22
  v_exp_f32 v23, v23
  v_fma_f32 v20, v20, v44, v44
  v_fma_f32 v21, v21, v44, v44
  v_fma_f32 v22, v22, v44, v44
  v_fma_f32 v23, v23, v44, v44
  v_rcp_f32 v20, v20
  v_rcp_f32 v21, v21
  global_load_dwordx4 v[252:255], v2, s[66:67] offset:1024 sc1
  v_rcp_f32 v22, v22
  v_rcp_f32 v23, v23
  v_mul_f32 v20, v20, v92
  v_mul_f32 v21, v21, v93
  v_mul_f32 v22, v22, v94
  v_mul_f32 v23, v23, v95
  v_cvt_pk_bf16_f32 v54, v20, v21
  v_cvt_pk_bf16_f32 v55, v22, v23
  global_store_dwordx4 v2, v[52:55], s[4:5] offset:3072 sc1
  s_setprio 1
  v_mfma_f32_32x32x16_bf16 v[64:79], v[96:99], v[24:27], 0
  v_mfma_f32_32x32x16_bf16 v[80:95], v[100:103], v[24:27], 0
  s_waitcnt vmcnt(13)
  v_max_u32 v11, v208, v209
  v_max3_u32 v11, v11, v210, v211
  s_waitcnt vmcnt(12)
  v_max3_u32 v11, v11, v212, v213
  v_max3_u32 v11, v11, v214, v215
  s_waitcnt vmcnt(11)
  v_max3_u32 v11, v11, v216, v217
  v_mfma_f32_32x32x16_bf16 v[64:79], v[104:107], v[28:31], v[64:79]
  v_max3_u32 v11, v11, v218, v219
  s_waitcnt vmcnt(10)
  v_max3_u32 v11, v11, v220, v221
  v_max3_u32 v11, v11, v222, v223
  s_waitcnt vmcnt(9)
  v_max3_u32 v11, v11, v224, v225
  v_mfma_f32_32x32x16_bf16 v[80:95], v[108:111], v[28:31], v[80:95]
  v_max3_u32 v11, v11, v226, v227
  s_waitcnt vmcnt(8)
  v_max3_u32 v11, v11, v228, v229
  v_max3_u32 v11, v11, v230, v231
  v_cmp_eq_u32 vcc, -1, v11
  s_cbranch_vccz Lc19
  s_mov_b32 s55, 20000
Lg00B:
  global_load_dwordx4 v[208:211], v2, s[56:57] offset:0 sc1
  global_load_dwordx4 v[212:215], v2, s[56:57] offset:1024 sc1
  global_load_dwordx4 v[216:219], v2, s[58:59] offset:0 sc1
  global_load_dwordx4 v[220:223], v2, s[58:59] offset:1024 sc1
  global_load_dwordx4 v[224:227], v2, s[60:61] offset:0 sc1
  global_load_dwordx4 v[228:231], v2, s[60:61] offset:1024 sc1
  s_waitcnt vmcnt(5)
  v_max_u32 v11, v208, v209
  v_max3_u32 v11, v11, v210, v211
  s_waitcnt vmcnt(4)
  v_max3_u32 v11, v11, v212, v213
  v_max3_u32 v11, v11, v214, v215
  s_waitcnt vmcnt(3)
  v_max3_u32 v11, v11, v216, v217
  v_max3_u32 v11, v11, v218, v219
  s_waitcnt vmcnt(2)
  v_max3_u32 v11, v11, v220, v221
  v_max3_u32 v11, v11, v222, v223
  s_waitcnt vmcnt(1)
  v_max3_u32 v11, v11, v224, v225
  v_max3_u32 v11, v11, v226, v227
  s_waitcnt vmcnt(0)
  v_max3_u32 v11, v11, v228, v229
  v_max3_u32 v11, v11, v230, v231
  v_cmp_eq_u32 vcc, -1, v11
  s_cbranch_vccz Lg00Bx
  s_sub_u32 s55, s55, 1
  s_cmp_lg_u32 s55, 0
  s_cbranch_scc1 Lg00B
Lg00Bx:
Lc19:
  v_mfma_f32_32x32x16_bf16 v[64:79], v[112:115], v[208:211], v[64:79]
  v_mfma_f32_32x32x16_bf16 v[80:95], v[116:119], v[208:211], v[80:95]
  v_mfma_f32_32x32x16_bf16 v[64:79], v[120:123], v[212:215], v[64:79]
  v_mfma_f32_32x32x16_bf16 v[80:95], v[124:127], v[212:215], v[80:95]
  v_mfma_f32_32x32x16_bf16 v[64:79], v[128:131], v[216:219], v[64:79]
  v_mfma_f32_32x32x16_bf16 v[80:95], v[132:135], v[216:219], v[80:95]
  v_mfma_f32_32x32x16_bf16 v[64:79], v[136:139], v[220:223], v[64:79]
  s_waitcnt vmcnt(6)
  v_max_u32 v11, v232, v233
  v_max3_u32 v11, v11, v234, v235
  s_waitcnt vmcnt(5)
  v_max3_u32 v11, v11, v236, v237
  v_mfma_f32_32x32x16_bf16 v[80:95], v[140:143], v[220:223], v[80:95]
  v_max3_u32 v11, v11, v238, v239
  s_waitcnt vmcnt(4)
  v_max3_u32 v11, v11, v240, v241
  v_mfma_f32_32x32x16_bf16 v[64:79], v[144:147], v[224:227], v[64:79]
  v_max3_u32 v11, v11, v242, v243
  s_waitcnt vmcnt(3)
  v_max3_u32 v11, v11, v244, v245
  v_mfma_f32_32x32x16_bf16 v[80:95], v[148:151], v[224:227], v[80:95]
  v_max3_u32 v11, v11, v246, v247
  s_waitcnt vmcnt(2)
  v_max3_u32 v11, v11, v248, v249
  v_mfma_f32_32x32x16_bf16 v[64:79], v[152:155], v[228:231], v[64:79]
  v_max3_u32 v11, v11, v250, v251
  s_waitcnt vmcnt(1)
  v_max3_u32 v11, v11, v252, v253
  v_mfma_f32_32x32x16_bf16 v[80:95], v[156:159], v[228:231], v[80:95]
  v_max3_u32 v11, v11, v254, v255
  v_cmp_eq_u32 vcc, -1, v11
  s_cbranch_vccz Lc20
  s_mov_b32 s55, 20000
Lg01B:
  global_load_dwordx4 v[232:235], v2, s[62:63] offset:0 sc1
  global_load_dwordx4 v[236:239], v2, s[62:63] offset:1024 sc1
  global_load_dwordx4 v[240:243], v2, s[64:65] offset:0 sc1
  global_load_dwordx4 v[244:247], v2, s[64:65] offset:1024 sc1
  global_load_dwordx4 v[248:251], v2, s[66:67] offset:0 sc1
  global_load_dwordx4 v[252:255], v2, s[66:67] offset:1024 sc1
  s_waitcnt vmcnt(5)
  v_max_u32 v11, v232, v233
  v_max3_u32 v11, v11, v234, v235
  s_waitcnt vmcnt(4)
  v_max3_u32 v11, v11, v236, v237
  v_max3_u32 v11, v11, v238, v239
  s_waitcnt vmcnt(3)
  v_max3_u32 v11, v11, v240, v241
  v_max3_u32 v11, v11, v242, v243
  s_waitcnt vmcnt(2)
  v_max3_u32 v11, v11, v244, v245
  v_max3_u32 v11, v11, v246, v247
  s_waitcnt vmcnt(1)
  v_max3_u32 v11, v11, v248, v249
  v_max3_u32 v11, v11, v250, v251
  s_waitcnt vmcnt(0)
  v_max3_u32 v11, v11, v252, v253
  v_max3_u32 v11, v11, v254, v255
  v_cmp_eq_u32 vcc, -1, v11
  s_cbranch_vccz Lg01Bx
  s_sub_u32 s55, s55, 1
  s_cmp_lg_u32 s55, 0
  s_cbranch_scc1 Lg01B
Lg01Bx:
Lc20:
  v_mfma_f32_32x32x16_bf16 v[64:79], v[160:163], v[232:235], v[64:79]
  v_mfma_f32_32x32x16_bf16 v[80:95], v[164:167], v[232:235], v[80:95]
  v_mfma_f32_32x32x16_bf16 v[64:79], v[168:171], v[236:239], v[64:79]
  v_mfma_f32_32x32x16_bf16 v[80:95], v[172:175], v[236:239], v[80:95]
  v_mfma_f32_32x32x16_bf16 v[64:79], v[176:179], v[240:243], v[64:79]
  v_mfma_f32_32x32x16_bf16 v[80:95], v[180:183], v[240:243], v[80:95]
  v_mfma_f32_32x32x16_bf16 v[64:79], v[184:187], v[244:247], v[64:79]
  v_mfma_f32_32x32x16_bf16 v[80:95], v[188:191], v[244:247], v[80:95]
  v_mfma_f32_32x32x16_bf16 v[64:79], v[192:195], v[248:251], v[64:79]
  v_mfma_f32_32x32x16_bf16 v[80:95], v[196:199], v[248:251], v[80:95]
  v_mfma_f32_32x32x16_bf16 v[64:79], v[200:203], v[252:255], v[64:79]
  v_mfma_f32_32x32x16_bf16 v[80:95], v[204:207], v[252:255], v[80:95]
  s_setprio 0
  s_nop 9
  v_cvt_pk_bf16_f32 v16, v64, v65
  v_cvt_pk_bf16_f32 v17, v66, v67
  v_cvt_pk_bf16_f32 v18, v68, v69
  v_cvt_pk_bf16_f32 v19, v70, v71
  ds_write_b128 v6, v[16:19] offset:0
  v_cvt_pk_bf16_f32 v20, v72, v73
  v_cvt_pk_bf16_f32 v21, v74, v75
  v_cvt_pk_bf16_f32 v22, v76, v77
  v_cvt_pk_bf16_f32 v23, v78, v79
  ds_write_b128 v6, v[20:23] offset:1152
  v_cvt_pk_bf16_f32 v24, v80, v81
  v_cvt_pk_bf16_f32 v25, v82, v83
  v_cvt_pk_bf16_f32 v26, v84, v85
  v_cvt_pk_bf16_f32 v27, v86, v87
  ds_write_b128 v6, v[24:27] offset:2304
  v_cvt_pk_bf16_f32 v28, v88, v89
  v_cvt_pk_bf16_f32 v29, v90, v91
  v_cvt_pk_bf16_f32 v30, v92, v93
  v_cvt_pk_bf16_f32 v31, v94, v95
  ds_write_b128 v6, v[28:31] offset:3456
  ds_read_b128 v[80:83], v7 offset:0
  v_lshlrev_b32 v64, 16, v40
  v_and_b32 v65, 0xffff0000, v40
  v_lshlrev_b32 v66, 16, v41
  v_and_b32 v67, 0xffff0000, v41
  v_lshlrev_b32 v68, 16, v42
  v_and_b32 v69, 0xffff0000, v42
  v_lshlrev_b32 v70, 16, v43
  v_and_b32 v71, 0xffff0000, v43
  s_waitcnt lgkmcnt(0)
  v_lshlrev_b32 v84, 16, v80
  v_and_b32 v85, 0xffff0000, v80
  v_add_f32 v64, v64, v84
  v_add_f32 v65, v65, v85
  v_lshlrev_b32 v86, 16, v81
  v_and_b32 v87, 0xffff0000, v81
  v_add_f32 v66, v66, v86
  v_add_f32 v67, v67, v87
  v_lshlrev_b32 v84, 16, v82
  v_and_b32 v85, 0xffff0000, v82
  v_add_f32 v68, v68, v84
  v_add_f32 v69, v69, v85
  v_lshlrev_b32 v86, 16, v83
  v_and_b32 v87, 0xffff0000, v83
  v_add_f32 v70, v70, v86
  v_add_f32 v71, v71, v87
  s_barrier
  ds_read_b128 v[16:19], v39 offset:0
  ds_read_b128 v[20:23], v39 offset:4608
  ds_read_b128 v[24:27], v39 offset:9216
  ds_read_b128 v[28:31], v39 offset:13824
  ds_read_b128 v[32:35], v39 offset:18432
  ds_read_b128 v[12:15], v39 offset:23040
  ds_read_b128 v[72:75], v39 offset:27648
  ds_read_b128 v[76:79], v39 offset:32256
  s_waitcnt lgkmcnt(7)
  v_lshlrev_b32 v84, 16, v16
  global_load_dwordx4 v[208:211], v2, s[56:57] offset:2048 sc1
  v_and_b32 v85, 0xffff0000, v16
  v_add_f32 v64, v64, v84
  v_add_f32 v65, v65, v85
  v_lshlrev_b32 v86, 16, v17
  v_and_b32 v87, 0xffff0000, v17
  global_load_dwordx4 v[212:215], v2, s[56:57] offset:3072 sc1
  v_add_f32 v66, v66, v86
  v_add_f32 v67, v67, v87
  v_lshlrev_b32 v84, 16, v18
  v_and_b32 v85, 0xffff0000, v18
  v_add_f32 v68, v68, v84
  global_load_dwordx4 v[216:219], v2, s[58:59] offset:2048 sc1
  v_add_f32 v69, v69, v85
  v_lshlrev_b32 v86, 16, v19
  v_and_b32 v87, 0xffff0000, v19
  v_add_f32 v70, v70, v86
  v_add_f32 v71, v71, v87
  global_load_dwordx4 v[220:223], v2, s[58:59] offset:3072 sc1
  s_waitcnt lgkmcnt(6)
  v_lshlrev_b32 v84, 16, v20
  v_and_b32 v85, 0xffff0000, v20
  v_add_f32 v64, v64, v84
  v_add_f32 v65, v65, v85
  v_lshlrev_b32 v86, 16, v21
  global_load_dwordx4 v[224:227], v2, s[60:61] offset:2048 sc1
  v_and_b32 v87, 0xffff0000, v21
  v_add_f32 v66, v66, v86
  v_add_f32 v67, v67, v87
  v_lshlrev_b32 v84, 16, v22
  v_and_b32 v85, 0xffff0000, v22
  global_load_dwordx4 v[228:231], v2, s[60:61] offset:3072 sc1
  v_add_f32 v68, v68, v84
  v_add_f32 v69, v69, v85
  v_lshlrev_b32 v86, 16, v23
  v_and_b32 v87, 0xffff0000, v23
  v_add_f32 v70, v70, v86
  global_load_dwordx4 v[232:235], v2, s[62:63] offset:2048 sc1
  v_add_f32 v71, v71, v87
  s_waitcnt lgkmcnt(5)
  v_lshlrev_b32 v84, 16, v24
  v_and_b32 v85, 0xffff0000, v24
  v_add_f32 v64, v64, v84
  v_add_f32 v65, v65, v85
  global_load_dwordx4 v[236:239], v2, s[62:63] offset:3072 sc1
  v_lshlrev_b32 v86, 16, v25
  v_and_b32 v87, 0xffff0000, v25
  v_add_f32 v66, v66, v86
  v_add_f32 v67, v67, v87
  v_lshlrev_b32 v84, 16, v26
  global_load_dwordx4 v[240:243], v2, s[64:65] offset:2048 sc1
  v_and_b32 v85, 0xffff0000, v26
  v_add_f32 v68, v68, v84
  v_add_f32 v69, v69, v85
  v_lshlrev_b32 v86, 16, v27
  v_and_b32 v87, 0xffff0000, v27
  global_load_dwordx4 v[244:247], v2, s[64:65] offset:3072 sc1
  v_add_f32 v70, v70, v86
  v_add_f32 v71, v71, v87
  s_waitcnt lgkmcnt(4)
  v_lshlrev_b32 v84, 16, v28
  v_and_b32 v85, 0xffff0000, v28
  v_add_f32 v64, v64, v84
  global_load_dwordx4 v[248:251], v2, s[66:67] offset:2048 sc1
  v_add_f32 v65, v65, v85
  v_lshlrev_b32 v86, 16, v29
  v_and_b32 v87, 0xffff0000, v29
  v_add_f32 v66, v66, v86
  v_add_f32 v67, v67, v87
  global_load_dwordx4 v[252:255], v2, s[66:67] offset:3072 sc1
  v_lshlrev_b32 v84, 16, v30
  v_and_b32 v85, 0xffff0000, v30
  v_add_f32 v68, v68, v84
  v_add_f32 v69, v69, v85
  v_lshlrev_b32 v86, 16, v31
  v_and_b32 v87, 0xffff0000, v31
  v_add_f32 v70, v70, v86
  v_add_f32 v71, v71, v87
  s_waitcnt lgkmcnt(3)
  v_lshlrev_b32 v84, 16, v32
  v_and_b32 v85, 0xffff0000, v32
  v_add_f32 v64, v64, v84
  v_add_f32 v65, v65, v85
  v_lshlrev_b32 v86, 16, v33
  v_and_b32 v87, 0xffff0000, v33
  v_add_f32 v66, v66, v86
  v_add_f32 v67, v67, v87
  v_lshlrev_b32 v84, 16, v34
  v_and_b32 v85, 0xffff0000, v34
  v_add_f32 v68, v68, v84
  v_add_f32 v69, v69, v85
  v_lshlrev_b32 v86, 16, v35
  v_and_b32 v87, 0xffff0000, v35
  v_add_f32 v70, v70, v86
  v_add_f32 v71, v71, v87
  s_waitcnt lgkmcnt(2)
  v_lshlrev_b32 v84, 16, v12
  v_and_b32 v85, 0xffff0000, v12
  v_add_f32 v64, v64, v84
  v_add_f32 v65, v65, v85
  v_lshlrev_b32 v86, 16, v13
  v_and_b32 v87, 0xffff0000, v13
  v_add_f32 v66, v66, v86
  v_add_f32 v67, v67, v87
  v_lshlrev_b32 v84, 16, v14
  v_and_b32 v85, 0xffff0000, v14
  v_add_f32 v68, v68, v84
  v_add_f32 v69, v69, v85
  v_lshlrev_b32 v86, 16, v15
  v_and_b32 v87, 0xffff0000, v15
  v_add_f32 v70, v70, v86
  v_add_f32 v71, v71, v87
  s_waitcnt lgkmcnt(1)
  v_lshlrev_b32 v84, 16, v72
  v_and_b32 v85, 0xffff0000, v72
  v_add_f32 v64, v64, v84
  v_add_f32 v65, v65, v85
  v_lshlrev_b32 v86, 16, v73
  v_and_b32 v87, 0xffff0000, v73
  v_add_f32 v66, v66, v86
  v_add_f32 v67, v67, v87
  v_lshlrev_b32 v84, 16, v74
  v_and_b32 v85, 0xffff0000, v74
  v_add_f32 v68, v68, v84
  v_add_f32 v69, v69, v85
  v_lshlrev_b32 v86, 16, v75
  v_and_b32 v87, 0xffff0000, v75
  v_add_f32 v70, v70, v86
  v_add_f32 v71, v71, v87
  s_waitcnt lgkmcnt(0)
  v_lshlrev_b32 v84, 16, v76
  v_and_b32 v85, 0xffff0000, v76
  v_add_f32 v64, v64, v84
  v_add_f32 v65, v65, v85
  v_lshlrev_b32 v86, 16, v77
  v_and_b32 v87, 0xffff0000, v77
  v_add_f32 v66, v66, v86
  v_add_f32 v67, v67, v87
  v_lshlrev_b32 v84, 16, v78
  v_and_b32 v85, 0xffff0000, v78
  v_add_f32 v68, v68, v84
  v_add_f32 v69, v69, v85
  v_lshlrev_b32 v86, 16, v79
  v_and_b32 v87, 0xffff0000, v79
  v_add_f32 v70, v70, v86
  v_add_f32 v71, v71, v87
  v_cvt_pk_bf16_f32 v88, v64, v65
  v_cvt_pk_bf16_f32 v89, v66, v67
  v_cvt_pk_bf16_f32 v90, v68, v69
  v_cvt_pk_bf16_f32 v91, v70, v71
  global_store_dwordx4 v3, v[88:91], s[68:69] offset:0 sc1
  s_setprio 1
  v_mfma_f32_32x32x16_bf16 v[64:79], v[96:99], v[48:51], 0
  v_mfma_f32_32x32x16_bf16 v[80:95], v[100:103], v[48:51], 0
  s_waitcnt vmcnt(12)
  v_max_u32 v11, v208, v209
  v_max3_u32 v11, v11, v210, v211
  s_waitcnt vmcnt(11)
  v_max3_u32 v11, v11, v212, v213
  v_max3_u32 v11, v11, v214, v215
  s_waitcnt vmcnt(10)
  v_max3_u32 v11, v11, v216, v217
  v_mfma_f32_32x32x16_bf16 v[64:79], v[104:107], v[52:55], v[64:79]
  v_max3_u32 v11, v11, v218, v219
  s_waitcnt vmcnt(9)
  v_max3_u32 v11, v11, v220, v221
  v_max3_u32 v11, v11, v222, v223
  s_waitcnt vmcnt(8)
  v_max3_u32 v11, v11, v224, v225
  v_mfma_f32_32x32x16_bf16 v[80:95], v[108:111], v[52:55], v[80:95]
  v_max3_u32 v11, v11, v226, v227
  s_waitcnt vmcnt(7)
  v_max3_u32 v11, v11, v228, v229
  v_max3_u32 v11, v11, v230, v231
  v_cmp_eq_u32 vcc, -1, v11
  s_cbranch_vccz Lc21
  s_mov_b32 s55, 20000
Lg10B:
  global_load_dwordx4 v[208:211], v2, s[56:57] offset:2048 sc1
  global_load_dwordx4 v[212:215], v2, s[56:57] offset:3072 sc1
  global_load_dwordx4 v[216:219], v2, s[58:59] offset:2048 sc1
  global_load_dwordx4 v[220:223], v2, s[58:59] offset:3072 sc1
  global_load_dwordx4 v[224:227], v2, s[60:61] offset:2048 sc1
  global_load_dwordx4 v[228:231], v2, s[60:61] offset:3072 sc1
  s_waitcnt vmcnt(5)
  v_max_u32 v11, v208, v209
  v_max3_u32 v11, v11, v210, v211
  s_waitcnt vmcnt(4)
  v_max3_u32 v11, v11, v212, v213
  v_max3_u32 v11, v11, v214, v215
  s_waitcnt vmcnt(3)
  v_max3_u32 v11, v11, v216, v217
  v_max3_u32 v11, v11, v218, v219
  s_waitcnt vmcnt(2)
  v_max3_u32 v11, v11, v220, v221
  v_max3_u32 v11, v11, v222, v223
  s_waitcnt vmcnt(1)
  v_max3_u32 v11, v11, v224, v225
  v_max3_u32 v11, v11, v226, v227
  s_waitcnt vmcnt(0)
  v_max3_u32 v11, v11, v228, v229
  v_max3_u32 v11, v11, v230, v231
  v_cmp_eq_u32 vcc, -1, v11
  s_cbranch_vccz Lg10Bx
  s_sub_u32 s55, s55, 1
  s_cmp_lg_u32 s55, 0
  s_cbranch_scc1 Lg10B
Lg10Bx:
Lc21:
  v_mfma_f32_32x32x16_bf16 v[64:79], v[112:115], v[208:211], v[64:79]
  v_mfma_f32_32x32x16_bf16 v[80:95], v[116:119], v[208:211], v[80:95]
  v_mfma_f32_32x32x16_bf16 v[64:79], v[120:123], v[212:215], v[64:79]
  v_mfma_f32_32x32x16_bf16 v[80:95], v[124:127], v[212:215], v[80:95]
  v_mfma_f32_32x32x16_bf16 v[64:79], v[128:131], v[216:219], v[64:79]
  v_mfma_f32_32x32x16_bf16 v[80:95], v[132:135], v[216:219], v[80:95]
  v_mfma_f32_32x32x16_bf16 v[64:79], v[136:139], v[220:223], v[64:79]
  s_waitcnt vmcnt(6)
  v_max_u32 v11, v232, v233
  v_max3_u32 v11, v11, v234, v235
  s_waitcnt vmcnt(5)
  v_max3_u32 v11, v11, v236, v237
  v_mfma_f32_32x32x16_bf16 v[80:95], v[140:143], v[220:223], v[80:95]
  v_max3_u32 v11, v11, v238, v239
  s_waitcnt vmcnt(4)
  v_max3_u32 v11, v11, v240, v241
  v_mfma_f32_32x32x16_bf16 v[64:79], v[144:147], v[224:227], v[64:79]
  v_max3_u32 v11, v11, v242, v243
  s_waitcnt vmcnt(3)
  v_max3_u32 v11, v11, v244, v245
  v_mfma_f32_32x32x16_bf16 v[80:95], v[148:151], v[224:227], v[80:95]
  v_max3_u32 v11, v11, v246, v247
  s_waitcnt vmcnt(2)
  v_max3_u32 v11, v11, v248, v249
  v_mfma_f32_32x32x16_bf16 v[64:79], v[152:155], v[228:231], v[64:79]
  v_max3_u32 v11, v11, v250, v251
  s_waitcnt vmcnt(1)
  v_max3_u32 v11, v11, v252, v253
  v_mfma_f32_32x32x16_bf16 v[80:95], v[156:159], v[228:231], v[80:95]
  s_barrier
  v_max3_u32 v11, v11, v254, v255
  v_cmp_eq_u32 vcc, -1, v11
  s_cbranch_vccz Lc22
  s_mov_b32 s55, 20000
Lg11B:
  global_load_dwordx4 v[232:235], v2, s[62:63] offset:2048 sc1
  global_load_dwordx4 v[236:239], v2, s[62:63] offset:3072 sc1
  global_load_dwordx4 v[240:243], v2, s[64:65] offset:2048 sc1
  global_load_dwordx4 v[244:247], v2, s[64:65] offset:3072 sc1
  global_load_dwordx4 v[248:251], v2, s[66:67] offset:2048 sc1
  global_load_dwordx4 v[252:255], v2, s[66:67] offset:3072 sc1
  s_waitcnt vmcnt(5)
  v_max_u32 v11, v232, v233
  v_max3_u32 v11, v11, v234, v235
  s_waitcnt vmcnt(4)
  v_max3_u32 v11, v11, v236, v237
  v_max3_u32 v11, v11, v238, v239
  s_waitcnt vmcnt(3)
  v_max3_u32 v11, v11, v240, v241
  v_max3_u32 v11, v11, v242, v243
  s_waitcnt vmcnt(2)
  v_max3_u32 v11, v11, v244, v245
  v_max3_u32 v11, v11, v246, v247
  s_waitcnt vmcnt(1)
  v_max3_u32 v11, v11, v248, v249
  v_max3_u32 v11, v11, v250, v251
  s_waitcnt vmcnt(0)
  v_max3_u32 v11, v11, v252, v253
  v_max3_u32 v11, v11, v254, v255
  v_cmp_eq_u32 vcc, -1, v11
  s_cbranch_vccz Lg11Bx
  s_sub_u32 s55, s55, 1
  s_cmp_lg_u32 s55, 0
  s_cbranch_scc1 Lg11B
Lg11Bx:
Lc22:
  v_mfma_f32_32x32x16_bf16 v[64:79], v[160:163], v[232:235], v[64:79]
  v_mfma_f32_32x32x16_bf16 v[80:95], v[164:167], v[232:235], v[80:95]
  v_mfma_f32_32x32x16_bf16 v[64:79], v[168:171], v[236:239], v[64:79]
  v_mfma_f32_32x32x16_bf16 v[80:95], v[172:175], v[236:239], v[80:95]
  v_mfma_f32_32x32x16_bf16 v[64:79], v[176:179], v[240:243], v[64:79]
  v_mfma_f32_32x32x16_bf16 v[80:95], v[180:183], v[240:243], v[80:95]
  v_mfma_f32_32x32x16_bf16 v[64:79], v[184:187], v[244:247], v[64:79]
  v_mfma_f32_32x32x16_bf16 v[80:95], v[188:191], v[244:247], v[80:95]
  v_mfma_f32_32x32x16_bf16 v[64:79], v[192:195], v[248:251], v[64:79]
  v_mfma_f32_32x32x16_bf16 v[80:95], v[196:199], v[248:251], v[80:95]
  v_mfma_f32_32x32x16_bf16 v[64:79], v[200:203], v[252:255], v[64:79]
  v_mfma_f32_32x32x16_bf16 v[80:95], v[204:207], v[252:255], v[80:95]
  v_add_u32 v6, 108544, v6
  s_nop 9
  v_cvt_pk_bf16_f32 v16, v64, v65
  v_cvt_pk_bf16_f32 v17, v66, v67
  v_cvt_pk_bf16_f32 v18, v68, v69
  v_cvt_pk_bf16_f32 v19, v70, v71
  ds_write_b128 v6, v[16:19] offset:0
  v_cvt_pk_bf16_f32 v20, v72, v73
  v_cvt_pk_bf16_f32 v21, v74, v75
  v_cvt_pk_bf16_f32 v22, v76, v77
  v_cvt_pk_bf16_f32 v23, v78, v79
  ds_write_b128 v6, v[20:23] offset:1152
  v_cvt_pk_bf16_f32 v24, v80, v81
  v_cvt_pk_bf16_f32 v25, v82, v83
  v_cvt_pk_bf16_f32 v26, v84, v85
  v_cvt_pk_bf16_f32 v27, v86, v87
  ds_write_b128 v6, v[24:27] offset:2304
  v_cvt_pk_bf16_f32 v28, v88, v89
  v_cvt_pk_bf16_f32 v29, v90, v91
  v_cvt_pk_bf16_f32 v30, v92, v93
  v_cvt_pk_bf16_f32 v31, v94, v95
  ds_write_b128 v6, v[28:31] offset:3456
  s_waitcnt lgkmcnt(0)
  s_barrier
  s_endpgm
Lhelper:
  s_min_u32 s50, s2, 27
  s_mul_i32 s42, s50, 57344
  s_add_u32 s52, s24, s42
  s_addc_u32 s53, s25, 0
  v_lshrrev_b32 v2, 3, v0
  v_and_b32 v3, 7, v0
  v_mul_u32_u24 v4, 896, v2
  v_lshl_add_u32 v4, v3, 4, v4
  v_mul_u32_u24 v5, 928, v2
  v_lshl_add_u32 v5, v3, 4, v5
  s_lshl_b32 s42, s3, 1
  s_add_u32 s42, s42, 134656
  s_add_u32 s46, s32, s42
  s_addc_u32 s47, s33, 0
  s_mul_i32 s42, s35, 1280
  s_add_u32 s42, s42, 129024
  v_mul_u32_u24 v15, 160, v15
  v_lshl_add_u32 v14, v14, 4, v15
  v_add_u32 v14, s42, v14
  v_and_b32 v15, 3, v1
  v_mul_u32_u24 v15, 320, v15
  v_lshrrev_b32 v16, 2, v1
  v_lshl_add_u32 v15, v16, 3, v15
  v_add_u32 v15, s42, v15
  s_waitcnt lgkmcnt(0)
  s_xor_b32 s34, s34, 0x5bd1e995
  s_cmp_eq_u32 s35, 7
  s_cbranch_scc1 Lc23
  s_waitcnt vmcnt(4)
  ds_write_b128 v14, v[64:67]
  ds_read_b32 v20, v15
  ds_read_b32 v22, v15 offset:160
  ds_read_b32 v24, v15 offset:4
  ds_read_b32 v26, v15 offset:164
  v_mov_b32 v21, s34
  v_mov_b32 v23, s34
  v_mov_b32 v25, s34
  v_mov_b32 v27, s34
  s_waitcnt lgkmcnt(2)
  global_store_dwordx4 v13, v[20:23], s[46:47] offset:-3584 sc1
  s_waitcnt lgkmcnt(0)
  global_store_dwordx4 v13, v[24:27], s[46:47] offset:3584 sc1
Lc23:
  s_cmp_eq_u32 s35, 7
  s_cbranch_scc0 Lc24
  v_mov_b32 v14, 0x3f803f80
  v_mov_b32 v16, 0
  v_mov_b32 v17, 0
  v_mov_b32 v18, 0
  v_mov_b32 v19, 0
  s_waitcnt vmcnt(10)
  v_dot2c_f32_bf16 v16, v64, v14
  v_dot2c_f32_bf16 v18, v64, v64
  v_dot2c_f32_bf16 v17, v65, v14
  v_dot2c_f32_bf16 v19, v65, v65
  v_dot2c_f32_bf16 v16, v66, v14
  v_dot2c_f32_bf16 v18, v66, v66
  v_dot2c_f32_bf16 v17, v67, v14
  v_dot2c_f32_bf16 v19, v67, v67
  s_waitcnt vmcnt(5)
  v_dot2c_f32_bf16 v16, v68, v14
  v_dot2c_f32_bf16 v18, v68, v68
  v_dot2c_f32_bf16 v17, v69, v14
  v_dot2c_f32_bf16 v19, v69, v69
  v_dot2c_f32_bf16 v16, v70, v14
  v_dot2c_f32_bf16 v18, v70, v70
  v_dot2c_f32_bf16 v17, v71, v14
  v_dot2c_f32_bf16 v19, v71, v71
  s_waitcnt vmcnt(4)
  v_dot2c_f32_bf16 v16, v72, v14
  v_dot2c_f32_bf16 v18, v72, v72
  v_dot2c_f32_bf16 v17, v73, v14
  v_dot2c_f32_bf16 v19, v73, v73
  v_dot2c_f32_bf16 v16, v74, v14
  v_dot2c_f32_bf16 v18, v74, v74
  v_dot2c_f32_bf16 v17, v75, v14
  v_dot2c_f32_bf16 v19, v75, v75
  s_waitcnt vmcnt(3)
  v_dot2c_f32_bf16 v16, v76, v14
  v_dot2c_f32_bf16 v18, v76, v76
  v_dot2c_f32_bf16 v17, v77, v14
  v_dot2c_f32_bf16 v19, v77, v77
  v_dot2c_f32_bf16 v16, v78, v14
  v_dot2c_f32_bf16 v18, v78, v78
  v_dot2c_f32_bf16 v17, v79, v14
  v_dot2c_f32_bf16 v19, v79, v79
  s_waitcnt vmcnt(2)
  v_dot2c_f32_bf16 v16, v80, v14
  v_dot2c_f32_bf16 v18, v80, v80
  v_dot2c_f32_bf16 v17, v81, v14
  v_dot2c_f32_bf16 v19, v81, v81
  v_dot2c_f32_bf16 v16, v82, v14
  v_dot2c_f32_bf16 v18, v82, v82
  v_dot2c_f32_bf16 v17, v83, v14
  v_dot2c_f32_bf16 v19, v83, v83
  s_waitcnt vmcnt(1)
  v_dot2c_f32_bf16 v16, v84, v14
  v_dot2c_f32_bf16 v18, v84, v84
  v_dot2c_f32_bf16 v17, v85, v14
  v_dot2c_f32_bf16 v19, v85, v85
  v_dot2c_f32_bf16 v16, v86, v14
  v_dot2c_f32_bf16 v18, v86, v86
  v_dot2c_f32_bf16 v17, v87, v14
  v_dot2c_f32_bf16 v19, v87, v87
  s_waitcnt vmcnt(0)
  v_dot2c_f32_bf16 v16, v88, v14
  v_dot2c_f32_bf16 v18, v88, v88
  v_dot2c_f32_bf16 v17, v89, v14
  v_dot2c_f32_bf16 v19, v89, v89
  v_dot2c_f32_bf16 v16, v90, v14
  v_dot2c_f32_bf16 v18, v90, v90
  v_dot2c_f32_bf16 v17, v91, v14
  v_dot2c_f32_bf16 v19, v91, v91
  s_nop 1
  v_add_f32 v16, v16, v17
  v_add_f32 v18, v18, v19
  s_nop 0
  v_add_f32_dpp v16, v16, v16 quad_perm:[1,0,3,2] row_mask:0xf bank_mask:0xf
  v_add_f32_dpp v18, v18, v18 quad_perm:[1,0,3,2] row_mask:0xf bank_mask:0xf
  s_nop 0
  v_add_f32_dpp v16, v16, v16 quad_perm:[2,3,0,1] row_mask:0xf bank_mask:0xf
  v_add_f32_dpp v18, v18, v18 quad_perm:[2,3,0,1] row_mask:0xf bank_mask:0xf
  s_nop 0
  v_add_f32_dpp v16, v16, v16 row_half_mirror row_mask:0xf bank_mask:0xf
  v_add_f32_dpp v18, v18, v18 row_half_mirror row_mask:0xf bank_mask:0xf
  v_mul_f32 v16, 0x3b124925, v16
  v_mul_f32 v18, 0x3b124925, v18
  v_fma_f32 v18, -v16, v16, v18
  v_max_f32 v18, 0, v18
  v_cvt_pk_bf16_f32 v18, v18, v18
  v_and_b32 v18, 0xffff0000, v18
  v_add_f32 v18, 0x3727c5ac, v18
  v_cvt_pk_bf16_f32 v18, v18, v18
  v_and_b32 v18, 0xffff0000, v18
  v_sqrt_f32 v18, v18
  v_mov_b32 v15, s34
  v_cvt_pk_bf16_f32 v14, v16, v18
  v_and_b32 v11, 7, v1
  v_cmp_eq_u32 vcc, 0, v11
  s_lshl_b32 s42, s2, 6
  s_add_u32 s42, s42, 65536
  s_add_u32 s46, s32, s42
  s_addc_u32 s47, s33, 0
  s_and_saveexec_b64 s[48:49], vcc
  global_store_dwordx2 v1, v[14:15], s[46:47] sc1
  s_mov_b64 exec, s[48:49]
Lc24:
  s_barrier
  global_load_dwordx4 v[96:99], v4, s[52:53] offset:0
  global_load_dwordx4 v[100:103], v4, s[52:53] offset:128
  global_load_dwordx4 v[104:107], v4, s[52:53] offset:256
  global_load_dwordx4 v[108:111], v4, s[52:53] offset:384
  global_load_dwordx4 v[112:115], v4, s[52:53] offset:512
  global_load_dwordx4 v[116:119], v4, s[52:53] offset:640
  global_load_dwordx4 v[120:123], v4, s[52:53] offset:768
  s_mul_i32 s42, s2, 229376
  s_add_u32 s42, s42, 10485760
  s_add_u32 s58, s32, s42
  s_addc_u32 s59, s33, 0
  v_mov_b32 v60, -1
  v_mov_b32 v61, -1
  v_mov_b32 v62, -1
  v_mov_b32 v63, -1
  s_cmp_ge_u32 s2, 28
  s_cbranch_scc1 Lc25
  s_and_b32 s42, s35, 1
  s_lshr_b32 s43, s35, 1
  s_lshl_b32 s44, s2, 1
  s_add_u32 s44, s44, s42
  s_lshr_b32 s45, s44, 3
  s_and_b32 s44, s44, 7
  s_mul_i32 s46, s42, 29696
  v_lshrrev_b32 v2, 5, v1
  v_bfe_u32 v3, v1, 2, 2
  v_lshl_add_u32 v2, v2, 2, v3
  v_mul_u32_u24 v2, 928, v2
  v_bfe_u32 v3, v1, 4, 1
  v_lshl_add_u32 v2, v3, 5, v2
  v_and_b32 v3, 1, v1
  v_lshl_add_u32 v2, v3, 4, v2
  v_bfe_u32 v3, v1, 1, 1
  v_lshl_add_u32 v2, v3, 3, v2
  s_lshr_b32 s47, s43, 1
  s_mul_i32 s47, s47, 14848
  s_and_b32 s48, s43, 1
  s_lshl_b32 s48, s48, 6
  s_add_u32 s47, s47, s48
  s_add_u32 s47, s47, s46
  v_add_u32 v7, s47, v2
  s_mul_i32 s47, s44, 28672
  s_lshl_b32 s48, s43, 10
  s_add_u32 s47, s47, s48
  s_add_u32 s47, s47, 6291456
  v_lshlrev_b32 v3, 4, v1
  s_waitcnt vmcnt(6)
  ds_write_b128 v5, v[96:99] offset:0
  s_waitcnt vmcnt(5)
  ds_write_b128 v5, v[100:103] offset:128
  s_waitcnt vmcnt(4)
  ds_write_b128 v5, v[104:107] offset:256
  s_waitcnt vmcnt(3)
  ds_write_b128 v5, v[108:111] offset:384
  s_waitcnt vmcnt(2)
  ds_write_b128 v5, v[112:115] offset:512
  s_waitcnt vmcnt(1)
  ds_write_b128 v5, v[116:119] offset:640
  s_waitcnt vmcnt(0)
  ds_write_b128 v5, v[120:123] offset:768
  s_waitcnt lgkmcnt(0)
  s_barrier
  ds_read_b64_tr_b16 v[128:129], v7 offset:0
  ds_read_b64_tr_b16 v[130:131], v7 offset:7424
  ds_read_b64_tr_b16 v[132:133], v7 offset:128
  ds_read_b64_tr_b16 v[134:135], v7 offset:7552
  ds_read_b64_tr_b16 v[136:137], v7 offset:256
  ds_read_b64_tr_b16 v[138:139], v7 offset:7680
  ds_read_b64_tr_b16 v[140:141], v7 offset:384
  ds_read_b64_tr_b16 v[142:143], v7 offset:7808
  ds_read_b64_tr_b16 v[144:145], v7 offset:512
  ds_read_b64_tr_b16 v[146:147], v7 offset:7936
  ds_read_b64_tr_b16 v[148:149], v7 offset:640
  ds_read_b64_tr_b16 v[150:151], v7 offset:8064
  ds_read_b64_tr_b16 v[152:153], v7 offset:768
  ds_read_b64_tr_b16 v[154:155], v7 offset:8192
  s_cmp_lt_u32 s45, 0
  s_cselect_b32 s42, 7, 0
  s_add_u32 s42, s42, s45
  s_lshl_b32 s42, s42, 12
  s_add_u32 s42, s42, s47
  s_add_u32 s42, s42, 0
  s_add_u32 s52, s32, s42
  s_addc_u32 s53, s33, 0
  s_waitcnt lgkmcnt(12)
  global_store_dwordx4 v3, v[128:131], s[52:53] sc1
  s_cmp_lt_u32 s45, 1
  s_cselect_b32 s42, 7, 0
  s_add_u32 s42, s42, s45
  s_lshl_b32 s42, s42, 12
  s_add_u32 s42, s42, s47
  s_add_u32 s42, s42, 225280
  s_add_u32 s54, s32, s42
  s_addc_u32 s55, s33, 0
  s_waitcnt lgkmcnt(10)
  global_store_dwordx4 v3, v[132:135], s[54:55] sc1
  s_cmp_lt_u32 s45, 2
  s_cselect_b32 s42, 7, 0
  s_add_u32 s42, s42, s45
  s_lshl_b32 s42, s42, 12
  s_add_u32 s42, s42, s47
  s_add_u32 s42, s42, 450560
  s_add_u32 s52, s32, s42
  s_addc_u32 s53, s33, 0
  s_waitcnt lgkmcnt(8)
  global_store_dwordx4 v3, v[136:139], s[52:53] sc1
  s_cmp_lt_u32 s45, 3
  s_cselect_b32 s42, 7, 0
  s_add_u32 s42, s42, s45
  s_lshl_b32 s42, s42, 12
  s_add_u32 s42, s42, s47
  s_add_u32 s42, s42, 675840
  s_add_u32 s54, s32, s42
  s_addc_u32 s55, s33, 0
  s_waitcnt lgkmcnt(6)
  global_store_dwordx4 v3, v[140:143], s[54:55] sc1
  s_cmp_lt_u32 s45, 4
  s_cselect_b32 s42, 7, 0
  s_add_u32 s42, s42, s45
  s_lshl_b32 s42, s42, 12
  s_add_u32 s42, s42, s47
  s_add_u32 s42, s42, 901120
  s_add_u32 s52, s32, s42
  s_addc_u32 s53, s33, 0
  s_waitcnt lgkmcnt(4)
  global_store_dwordx4 v3, v[144:147], s[52:53] sc1
  s_cmp_lt_u32 s45, 5
  s_cselect_b32 s42, 7, 0
  s_add_u32 s42, s42, s45
  s_lshl_b32 s42, s42, 12
  s_add_u32 s42, s42, s47
  s_add_u32 s42, s42, 1126400
  s_add_u32 s54, s32, s42
  s_addc_u32 s55, s33, 0
  s_waitcnt lgkmcnt(2)
  global_store_dwordx4 v3, v[148:151], s[54:55] sc1
  s_cmp_lt_u32 s45, 6
  s_cselect_b32 s42, 7, 0
  s_add_u32 s42, s42, s45
  s_lshl_b32 s42, s42, 12
  s_add_u32 s42, s42, s47
  s_add_u32 s42, s42, 1351680
  s_add_u32 s52, s32, s42
  s_addc_u32 s53, s33, 0
  s_waitcnt lgkmcnt(0)
  global_store_dwordx4 v3, v[152:155], s[52:53] sc1
Lc25:
  global_store_dwordx4 v13, v[60:63], s[58:59] sc1
  s_add_u32 s58, s58, 8192
  s_addc_u32 s59, s59, 0
  global_store_dwordx4 v13, v[60:63], s[58:59] sc1
  s_add_u32 s58, s58, 8192
  s_addc_u32 s59, s59, 0
  global_store_dwordx4 v13, v[60:63], s[58:59] sc1
  s_add_u32 s58, s58, 8192
  s_addc_u32 s59, s59, 0
  global_store_dwordx4 v13, v[60:63], s[58:59] sc1
  s_add_u32 s58, s58, 8192
  s_addc_u32 s59, s59, 0
  s_waitcnt vmcnt(4)
  s_barrier
  s_cmp_lg_u32 s35, 0
  s_cbranch_scc1 Lc26
  s_lshl_b32 s42, s2, 7
  s_add_u32 s42, s42, 32768
  s_add_u32 s52, s32, s42
  s_addc_u32 s53, s33, 0
  v_mov_b32 v2, 0
  v_mov_b32 v3, s34
  s_mov_b64 exec, 1
  global_store_dword v2, v3, s[52:53] sc1
  s_mov_b64 exec, -1
Lc26:
  s_mov_b32 s55, 24
Lpf:
  global_store_dwordx4 v13, v[60:63], s[58:59] sc1
  s_add_u32 s58, s58, 8192
  s_addc_u32 s59, s59, 0
  s_sub_u32 s55, s55, 1
  s_cmp_lg_u32 s55, 0
  s_cbranch_scc1 Lpf
  s_waitcnt vmcnt(0)
  s_barrier
  s_cmp_lg_u32 s35, 0
  s_cbranch_scc1 Lc27
  s_lshl_b32 s42, s2, 7
  s_add_u32 s42, s42, 36864
  s_add_u32 s52, s32, s42
  s_addc_u32 s53, s33, 0
  v_mov_b32 v2, 0
  v_mov_b32 v3, s34
  s_mov_b64 exec, 1
  global_store_dword v2, v3, s[52:53] sc1
  s_mov_b64 exec, -1
Lc27:
  s_endpgm
Lend:
  s_endpgm

.section .rodata,"a"
.p2align 6
.amdhsa_kernel sequential_preLN__ssm_conv_s4d__mixer_channel_mlp__prompt_kernel
  .amdhsa_next_free_vgpr 256
  .amdhsa_next_free_sgpr 102
  .amdhsa_accum_offset 256
  .amdhsa_group_segment_fixed_size 0
  .amdhsa_kernarg_size 120
  .amdhsa_user_sgpr_count 2
  .amdhsa_user_sgpr_kernarg_segment_ptr 1
  .amdhsa_system_sgpr_workgroup_id_x 1
.end_amdhsa_kernel
```
